```python
import torch

def _softmax(x, axis=-1):
    return torch.softmax(x, dim=axis)
def _gelu(x):
    return torch.nn.functional.gelu(x, approximate="tanh")
def _silu(x):
    return torch.nn.functional.silu(x)
def _sigmoid(x):
    return torch.sigmoid(x)
def _layernorm(x, axis=-1, eps=1e-5):
    m = x.mean(dim=axis, keepdim=True)
    v = x.var(dim=axis, keepdim=True, unbiased=False)
    return (x - m) / torch.sqrt(v + eps)
def _scatter_add(tgt, idx, src, axis=0):
    return tgt.clone().index_add_(axis, idx, src)
def _segment_sum(src, seg, n):
    out = torch.zeros((n,) + src.shape[1:], dtype=src.dtype)
    return out.index_add_(0, seg, src)
def _pad(x, pw):
    flat = tuple(v for pair in reversed(pw) for v in pair)
    return torch.nn.functional.pad(x, flat)

kernel_name = 'standalone__gqa_softmax__prompt'

def setup_inputs():

    _w = (lambda a: (lambda t: t.to(torch.bfloat16) if t.is_floating_point() else t)(torch.as_tensor(a)))
    B, Hq, Hkv, Sq, Sk, D = 1, 32, 4, 2048, 2048, 128
    return {
        "q": _w((lambda *s: torch.randn(*s, dtype=torch.bfloat16) * 0.8)(B, Hq, Sq, D)),
        "k": _w((lambda *s: torch.randn(*s, dtype=torch.bfloat16) * 0.8)(B, Hkv, Sk, D)),
        "v": _w((lambda *s: torch.randn(*s, dtype=torch.bfloat16) * 0.05)(B, Hkv, Sk, D)),
    }

def reference(q, k, v):
    B, Hq, Sq, D = q.shape
    Hkv = k.shape[1]
    rep = Hq // Hkv
    k = (lambda x, n, axis: torch.repeat_interleave(x, n, dim=axis))(k, rep, axis=1)
    v = (lambda x, n, axis: torch.repeat_interleave(x, n, dim=axis))(v, rep, axis=1)
    scale = D ** -0.5
    scores = torch.einsum("bhqd,bhkd->bhqk", q, k) * scale
    p = _softmax(scores, axis=-1)
    return torch.einsum("bhqk,bhkd->bhqd", p, v)
```

```asm
; @launch grid=(256,1,1) block=(256,1,1) lds=131136
.amdgcn_target "amdgcn-amd-amdhsa--gfx950"
.text
.globl standalone__gqa_softmax__prompt_kernel
.p2align 8
.type standalone__gqa_softmax__prompt_kernel,@function
standalone__gqa_softmax__prompt_kernel:
  s_cmp_ge_u32 s2, 0x100
  s_cbranch_scc1 L_end
  s_load_dwordx8 s[4:11], s[0:1], 0
  v_lshrrev_b32 v1, 6, v0
  v_and_b32 v2, 63, v0
  v_readfirstlane_b32 s28, v1
  v_and_b32 v3, 15, v2
  v_lshrrev_b32 v4, 4, v2
  s_getpc_b64 s[36:37]
L_pc:
  v_min_u32 v186, (L_codeend-L_pc-4)/128, v0
  v_lshlrev_b32 v186, 7, v186
  v_mov_b32 v187, s37
  v_add_co_u32 v186, vcc, s36, v186
  s_nop 1
  v_addc_co_u32 v187, vcc, 0, v187, vcc
  global_load_dword v185, v[186:187], off
  s_bfe_u32 s50, s2, 0x20001
  s_and_b32 s51, s2, 1
  s_lshl_b32 s51, s51, 5
  s_lshr_b32 s52, s2, 3
  s_or_b32 s51, s51, s52
  s_lshl_b32 s52, s50, 6
  s_add_u32 s51, s51, s52
  s_lshl_b32 s51, s51, 16
  s_lshl_b32 s50, s50, 19
  s_lshl_b32 s34, s28, 12
  s_lshl_b32 s44, s28, 14
  s_add_u32 s44, s34, 0
  s_add_u32 s45, s34, 16384
  s_add_u32 s46, s34, 32768
  s_add_u32 s47, s34, 49152
  s_mov_b32 s29, s34
  s_mov_b32 s30, s34
  s_lshl_b32 s53, s28, 2
  v_add_u32 v5, s53, v4
  v_xor_b32 v5, v5, v3
  v_lshlrev_b32 v6, 8, v4
  v_lshl_add_u32 v180, v5, 4, v6
  v_add_u32 v5, 0, v4
  v_xor_b32 v5, v5, v3
  v_lshl_add_u32 v8, v5, 4, v6
  v_add_u32 v5, 4, v4
  v_xor_b32 v5, v5, v3
  v_lshl_add_u32 v9, v5, 4, v6
  v_add_u32 v5, 8, v4
  v_xor_b32 v5, v5, v3
  v_lshl_add_u32 v10, v5, 4, v6
  v_add_u32 v5, 12, v4
  v_xor_b32 v5, v5, v3
  v_lshl_add_u32 v11, v5, 4, v6
  s_waitcnt lgkmcnt(0)
  s_load_dwordx8 s[92:99], s[8:9], s50
  s_add_u32 s16, s6, s50
  s_addc_u32 s17, s7, 0
  s_mov_b32 s18, 524288
  s_mov_b32 s19, 0x20000
  s_pack_ll_b32_b16 m0, s29, 0
  s_nop 0
  buffer_load_dwordx4 v180, s[16:19], s29 offen offset:0 lds
  buffer_load_dwordx4 v180, s[16:19], s29 offen offset:1024 lds
  buffer_load_dwordx4 v180, s[16:19], s29 offen offset:2048 lds
  buffer_load_dwordx4 v180, s[16:19], s29 offen offset:3072 lds
  s_addk_i32 s29, 0x4000
  s_add_u32 s12, s4, s51
  s_addc_u32 s13, s5, 0
  s_mov_b32 s14, 65536
  s_mov_b32 s15, 0x20000
  s_add_u32 m0, s34, 49152
  s_nop 0
  buffer_load_dwordx4 v8, s[12:15], s44 offen offset:0 nt lds
  buffer_load_dwordx4 v9, s[12:15], s44 offen offset:1024 nt lds
  buffer_load_dwordx4 v10, s[12:15], s44 offen offset:2048 nt lds
  buffer_load_dwordx4 v11, s[12:15], s44 offen offset:3072 nt lds
  s_add_u32 m0, s34, 81920
  s_nop 0
  buffer_load_dwordx4 v8, s[12:15], s45 offen offset:0 nt lds
  buffer_load_dwordx4 v9, s[12:15], s45 offen offset:1024 nt lds
  buffer_load_dwordx4 v10, s[12:15], s45 offen offset:2048 nt lds
  buffer_load_dwordx4 v11, s[12:15], s45 offen offset:3072 nt lds
  s_add_u32 s20, s8, s50
  s_addc_u32 s21, s9, 0
  s_mov_b32 s22, 524288
  s_mov_b32 s23, 0x20000
  s_add_u32 s24, s10, s51
  s_addc_u32 s25, s11, 0
  s_mov_b32 s26, 65536
  s_mov_b32 s27, 0x20000
  s_and_b32 s53, s28, 1
  s_lshl_b32 s53, s53, 2
  v_add_u32 v5, s53, v4
  v_lshlrev_b32 v5, 1, v5
  v_xor_b32 v5, v5, v3
  v_lshl_add_u32 v181, v5, 4, v6
  v_lshrrev_b32 v5, 2, v3
  v_lshlrev_b32 v5, 12, v5
  v_and_b32 v6, 3, v3
  v_lshl_add_u32 v5, v6, 8, v5
  v_lshl_add_u32 v7, v3, 8, s34
  v_add_u32 v6, 0, v4
  v_xor_b32 v6, v6, v3
  v_lshl_add_u32 v168, v6, 4, v5
  v_lshl_add_u32 v12, v6, 4, v7
  v_add_u32 v12, 49152, v12
  v_add_u32 v6, 4, v4
  v_xor_b32 v6, v6, v3
  v_lshl_add_u32 v169, v6, 4, v5
  v_lshl_add_u32 v13, v6, 4, v7
  v_add_u32 v13, 49152, v13
  v_add_u32 v6, 8, v4
  v_xor_b32 v6, v6, v3
  v_lshl_add_u32 v170, v6, 4, v5
  v_lshl_add_u32 v14, v6, 4, v7
  v_add_u32 v14, 49152, v14
  v_add_u32 v6, 12, v4
  v_xor_b32 v6, v6, v3
  v_lshl_add_u32 v171, v6, 4, v5
  v_lshl_add_u32 v15, v6, 4, v7
  v_add_u32 v15, 49152, v15
  v_lshrrev_b32 v5, 1, v4
  v_xor_b32 v5, v5, v3
  v_lshl_add_u32 v5, v5, 4, v7
  v_and_b32 v6, 1, v4
  v_lshl_add_u32 v182, v6, 3, v5
  v_xor_b32 v5, v3, v4
  v_lshlrev_b32 v5, 4, v5
  v_lshl_add_u32 v5, v4, 8, v5
  v_add_u32 v183, s34, v5
  v_xor_b32 v160, 0, v182
  v_xor_b32 v161, 32, v182
  v_xor_b32 v162, 64, v182
  v_xor_b32 v163, 96, v182
  v_xor_b32 v164, 128, v182
  v_xor_b32 v165, 160, v182
  v_xor_b32 v166, 192, v182
  v_xor_b32 v167, 224, v182
  v_xor_b32 v191, 192, v183
  v_xor_b32 v190, 128, v183
  v_xor_b32 v182, 0, v183
  v_xor_b32 v183, 64, v183
  v_lshlrev_b32 v184, 4, v2
  v_lshrrev_b32 v5, 2, v3
  v_and_b32 v6, 1, v4
  v_lshl_add_u32 v6, v6, 2, v5
  v_lshl_add_u32 v5, v4, 4, v5
  v_lshlrev_b32 v5, 8, v5
  v_and_b32 v7, 3, v3
  v_lshl_add_u32 v5, v7, 3, v5
  v_add_u32 v5, 65536, v5
  v_xor_b32 v7, 0, v6
  v_lshl_add_u32 v172, v7, 5, v5
  v_xor_b32 v7, 1, v6
  v_lshl_add_u32 v173, v7, 5, v5
  v_xor_b32 v7, 2, v6
  v_lshl_add_u32 v174, v7, 5, v5
  v_xor_b32 v7, 3, v6
  v_lshl_add_u32 v175, v7, 5, v5
  v_xor_b32 v7, 4, v6
  v_lshl_add_u32 v176, v7, 5, v5
  v_xor_b32 v7, 5, v6
  v_lshl_add_u32 v177, v7, 5, v5
  v_xor_b32 v7, 6, v6
  v_lshl_add_u32 v178, v7, 5, v5
  v_xor_b32 v7, 7, v6
  v_lshl_add_u32 v179, v7, 5, v5
  v_accvgpr_write_b32 a224, 0
  v_accvgpr_write_b32 a225, 0
  v_accvgpr_write_b32 a226, 0
  v_accvgpr_write_b32 a227, 0
  v_accvgpr_write_b32 a228, 0
  v_accvgpr_write_b32 a229, 0
  v_accvgpr_write_b32 a230, 0
  v_accvgpr_write_b32 a231, 0
  v_accvgpr_write_b32 a232, 0
  v_accvgpr_write_b32 a233, 0
  v_accvgpr_write_b32 a234, 0
  v_accvgpr_write_b32 a235, 0
  v_accvgpr_write_b32 a236, 0
  v_accvgpr_write_b32 a237, 0
  v_accvgpr_write_b32 a238, 0
  v_accvgpr_write_b32 a239, 0
  v_mov_b32 v5, 0x3f803f80
  v_and_b32 v6, 1, v3
  v_mov_b32 v7, 0xeeeeeeee
  v_mov_b32 v189, 0x44444444
  v_cmp_eq_u32 vcc, 1, v6
  s_nop 1
  v_cndmask_b32 v189, v189, v7, vcc
  v_accvgpr_write_b32 a240, v5
  v_accvgpr_write_b32 a241, v5
  v_accvgpr_write_b32 a242, v5
  v_accvgpr_write_b32 a243, v5
  s_mov_b32 s40, 0x3e0293ee
  s_mov_b32 s41, s40
  s_mov_b32 s39, 0xffff0000
  s_mov_b32 s31, 15
  s_mov_b32 s32, 0
  s_and_b32 s48, s28, 1
  s_mov_b32 s35, 0x44800000
  s_mov_b32 s33, 0x8000
  s_add_u32 m0, s34, 98304
  s_nop 0
  buffer_load_dwordx4 v8, s[12:15], s46 offen offset:0 nt lds
  buffer_load_dwordx4 v9, s[12:15], s46 offen offset:1024 nt lds
  buffer_load_dwordx4 v10, s[12:15], s46 offen offset:2048 nt lds
  buffer_load_dwordx4 v11, s[12:15], s46 offen offset:3072 nt lds
  s_waitcnt lgkmcnt(0)
  s_mov_b32 s52, 0
  s_lshl_b32 s53, s92, 16
  s_and_b32 s53, s53, 0x7f800000
  s_and_b32 s54, s92, 0x7f800000
  s_max_u32 s52, s52, s53
  s_max_u32 s52, s52, s54
  s_lshl_b32 s53, s93, 16
  s_and_b32 s53, s53, 0x7f800000
  s_and_b32 s54, s93, 0x7f800000
  s_max_u32 s52, s52, s53
  s_max_u32 s52, s52, s54
  s_lshl_b32 s53, s94, 16
  s_and_b32 s53, s53, 0x7f800000
  s_and_b32 s54, s94, 0x7f800000
  s_max_u32 s52, s52, s53
  s_max_u32 s52, s52, s54
  s_lshl_b32 s53, s95, 16
  s_and_b32 s53, s53, 0x7f800000
  s_and_b32 s54, s95, 0x7f800000
  s_max_u32 s52, s52, s53
  s_max_u32 s52, s52, s54
  s_lshl_b32 s53, s96, 16
  s_and_b32 s53, s53, 0x7f800000
  s_and_b32 s54, s96, 0x7f800000
  s_max_u32 s52, s52, s53
  s_max_u32 s52, s52, s54
  s_lshl_b32 s53, s97, 16
  s_and_b32 s53, s53, 0x7f800000
  s_and_b32 s54, s97, 0x7f800000
  s_max_u32 s52, s52, s53
  s_max_u32 s52, s52, s54
  s_lshl_b32 s53, s98, 16
  s_and_b32 s53, s53, 0x7f800000
  s_and_b32 s54, s98, 0x7f800000
  s_max_u32 s52, s52, s53
  s_max_u32 s52, s52, s54
  s_lshl_b32 s53, s99, 16
  s_and_b32 s53, s53, 0x7f800000
  s_and_b32 s54, s99, 0x7f800000
  s_max_u32 s52, s52, s53
  s_max_u32 s52, s52, s54
  s_add_u32 s52, s52, 0xd000000
  s_min_u32 s52, s52, 0x70000000
  s_or_b32 s52, s52, 0x400000
  s_or_b32 s43, s52, 0x80000000
  v_mov_b32 v6, s52
  v_accvgpr_write_b32 a0, v6
  v_accvgpr_write_b32 a1, v6
  v_accvgpr_write_b32 a2, v6
  v_accvgpr_write_b32 a3, v6
  v_accvgpr_write_b32 a4, v6
  v_accvgpr_write_b32 a5, v6
  v_accvgpr_write_b32 a6, v6
  v_accvgpr_write_b32 a7, v6
  v_accvgpr_write_b32 a8, v6
  v_accvgpr_write_b32 a9, v6
  v_accvgpr_write_b32 a10, v6
  v_accvgpr_write_b32 a11, v6
  v_accvgpr_write_b32 a12, v6
  v_accvgpr_write_b32 a13, v6
  v_accvgpr_write_b32 a14, v6
  v_accvgpr_write_b32 a15, v6
  v_accvgpr_write_b32 a16, v6
  v_accvgpr_write_b32 a17, v6
  v_accvgpr_write_b32 a18, v6
  v_accvgpr_write_b32 a19, v6
  v_accvgpr_write_b32 a20, v6
  v_accvgpr_write_b32 a21, v6
  v_accvgpr_write_b32 a22, v6
  v_accvgpr_write_b32 a23, v6
  v_accvgpr_write_b32 a24, v6
  v_accvgpr_write_b32 a25, v6
  v_accvgpr_write_b32 a26, v6
  v_accvgpr_write_b32 a27, v6
  v_accvgpr_write_b32 a28, v6
  v_accvgpr_write_b32 a29, v6
  v_accvgpr_write_b32 a30, v6
  v_accvgpr_write_b32 a31, v6
  v_accvgpr_write_b32 a32, v6
  v_accvgpr_write_b32 a33, v6
  v_accvgpr_write_b32 a34, v6
  v_accvgpr_write_b32 a35, v6
  v_accvgpr_write_b32 a36, v6
  v_accvgpr_write_b32 a37, v6
  v_accvgpr_write_b32 a38, v6
  v_accvgpr_write_b32 a39, v6
  v_accvgpr_write_b32 a40, v6
  v_accvgpr_write_b32 a41, v6
  v_accvgpr_write_b32 a42, v6
  v_accvgpr_write_b32 a43, v6
  v_accvgpr_write_b32 a44, v6
  v_accvgpr_write_b32 a45, v6
  v_accvgpr_write_b32 a46, v6
  v_accvgpr_write_b32 a47, v6
  v_accvgpr_write_b32 a48, v6
  v_accvgpr_write_b32 a49, v6
  v_accvgpr_write_b32 a50, v6
  v_accvgpr_write_b32 a51, v6
  v_accvgpr_write_b32 a52, v6
  v_accvgpr_write_b32 a53, v6
  v_accvgpr_write_b32 a54, v6
  v_accvgpr_write_b32 a55, v6
  v_accvgpr_write_b32 a56, v6
  v_accvgpr_write_b32 a57, v6
  v_accvgpr_write_b32 a58, v6
  v_accvgpr_write_b32 a59, v6
  v_accvgpr_write_b32 a60, v6
  v_accvgpr_write_b32 a61, v6
  v_accvgpr_write_b32 a62, v6
  v_accvgpr_write_b32 a63, v6
  v_accvgpr_write_b32 a64, v6
  v_accvgpr_write_b32 a65, v6
  v_accvgpr_write_b32 a66, v6
  v_accvgpr_write_b32 a67, v6
  v_accvgpr_write_b32 a68, v6
  v_accvgpr_write_b32 a69, v6
  v_accvgpr_write_b32 a70, v6
  v_accvgpr_write_b32 a71, v6
  v_accvgpr_write_b32 a72, v6
  v_accvgpr_write_b32 a73, v6
  v_accvgpr_write_b32 a74, v6
  v_accvgpr_write_b32 a75, v6
  v_accvgpr_write_b32 a76, v6
  v_accvgpr_write_b32 a77, v6
  v_accvgpr_write_b32 a78, v6
  v_accvgpr_write_b32 a79, v6
  v_accvgpr_write_b32 a80, v6
  v_accvgpr_write_b32 a81, v6
  v_accvgpr_write_b32 a82, v6
  v_accvgpr_write_b32 a83, v6
  v_accvgpr_write_b32 a84, v6
  v_accvgpr_write_b32 a85, v6
  v_accvgpr_write_b32 a86, v6
  v_accvgpr_write_b32 a87, v6
  v_accvgpr_write_b32 a88, v6
  v_accvgpr_write_b32 a89, v6
  v_accvgpr_write_b32 a90, v6
  v_accvgpr_write_b32 a91, v6
  v_accvgpr_write_b32 a92, v6
  v_accvgpr_write_b32 a93, v6
  v_accvgpr_write_b32 a94, v6
  v_accvgpr_write_b32 a95, v6
  v_accvgpr_write_b32 a96, v6
  v_accvgpr_write_b32 a97, v6
  v_accvgpr_write_b32 a98, v6
  v_accvgpr_write_b32 a99, v6
  v_accvgpr_write_b32 a100, v6
  v_accvgpr_write_b32 a101, v6
  v_accvgpr_write_b32 a102, v6
  v_accvgpr_write_b32 a103, v6
  v_accvgpr_write_b32 a104, v6
  v_accvgpr_write_b32 a105, v6
  v_accvgpr_write_b32 a106, v6
  v_accvgpr_write_b32 a107, v6
  v_accvgpr_write_b32 a108, v6
  v_accvgpr_write_b32 a109, v6
  v_accvgpr_write_b32 a110, v6
  v_accvgpr_write_b32 a111, v6
  v_accvgpr_write_b32 a112, v6
  v_accvgpr_write_b32 a113, v6
  v_accvgpr_write_b32 a114, v6
  v_accvgpr_write_b32 a115, v6
  v_accvgpr_write_b32 a116, v6
  v_accvgpr_write_b32 a117, v6
  v_accvgpr_write_b32 a118, v6
  v_accvgpr_write_b32 a119, v6
  v_accvgpr_write_b32 a120, v6
  v_accvgpr_write_b32 a121, v6
  v_accvgpr_write_b32 a122, v6
  v_accvgpr_write_b32 a123, v6
  v_accvgpr_write_b32 a124, v6
  v_accvgpr_write_b32 a125, v6
  v_accvgpr_write_b32 a126, v6
  v_accvgpr_write_b32 a127, v6
  s_add_u32 m0, s34, 114688
  s_nop 0
  buffer_load_dwordx4 v8, s[12:15], s47 offen offset:0 nt lds
  buffer_load_dwordx4 v9, s[12:15], s47 offen offset:1024 nt lds
  buffer_load_dwordx4 v10, s[12:15], s47 offen offset:2048 nt lds
  buffer_load_dwordx4 v11, s[12:15], s47 offen offset:3072 nt lds
  s_waitcnt vmcnt(12)
  ds_read_b128 v[192:195], v12 offset:0
  ds_read_b128 v[196:199], v13 offset:0
  ds_read_b128 v[200:203], v14 offset:0
  ds_read_b128 v[204:207], v15 offset:0
  s_barrier
  ds_read_b128 a[128:131], v168 offset:0
  ds_read_b128 a[132:135], v169 offset:0
  ds_read_b128 a[136:139], v170 offset:0
  ds_read_b128 a[140:143], v171 offset:0
  ds_read_b128 a[144:147], v168 offset:1024
  ds_read_b128 a[148:151], v169 offset:1024
  ds_read_b128 a[152:155], v170 offset:1024
  ds_read_b128 a[156:159], v171 offset:1024
  ds_read_b128 a[160:163], v168 offset:2048
  ds_read_b128 a[164:167], v169 offset:2048
  ds_read_b128 a[168:171], v170 offset:2048
  ds_read_b128 a[172:175], v171 offset:2048
  ds_read_b128 a[176:179], v168 offset:3072
  ds_read_b128 a[180:183], v169 offset:3072
  ds_read_b128 a[184:187], v170 offset:3072
  ds_read_b128 a[188:191], v171 offset:3072
  s_waitcnt lgkmcnt(14)
  v_lshlrev_b32 v112, 16, v192
  v_and_b32 v113, s39, v192
  v_lshlrev_b32 v114, 16, v193
  v_and_b32 v115, s39, v193
  v_lshlrev_b32 v116, 16, v194
  v_and_b32 v117, s39, v194
  v_lshlrev_b32 v118, 16, v195
  v_and_b32 v119, s39, v195
  v_pk_mul_f32 v[112:113], v[112:113], s[40:41]
  v_pk_mul_f32 v[114:115], v[114:115], s[40:41]
  v_pk_mul_f32 v[116:117], v[116:117], s[40:41]
  v_pk_mul_f32 v[118:119], v[118:119], s[40:41]
  v_cvt_pk_bf16_f32 v192, v112, v113
  v_cvt_pk_bf16_f32 v193, v114, v115
  v_cvt_pk_bf16_f32 v194, v116, v117
  v_cvt_pk_bf16_f32 v195, v118, v119
  v_lshlrev_b32 v120, 16, v196
  v_and_b32 v121, s39, v196
  v_lshlrev_b32 v122, 16, v197
  v_and_b32 v123, s39, v197
  v_lshlrev_b32 v124, 16, v198
  v_and_b32 v125, s39, v198
  v_lshlrev_b32 v126, 16, v199
  v_and_b32 v127, s39, v199
  v_pk_mul_f32 v[120:121], v[120:121], s[40:41]
  v_pk_mul_f32 v[122:123], v[122:123], s[40:41]
  v_pk_mul_f32 v[124:125], v[124:125], s[40:41]
  v_pk_mul_f32 v[126:127], v[126:127], s[40:41]
  v_cvt_pk_bf16_f32 v196, v120, v121
  v_cvt_pk_bf16_f32 v197, v122, v123
  v_cvt_pk_bf16_f32 v198, v124, v125
  v_cvt_pk_bf16_f32 v199, v126, v127
  v_lshlrev_b32 v128, 16, v200
  v_and_b32 v129, s39, v200
  v_lshlrev_b32 v130, 16, v201
  v_and_b32 v131, s39, v201
  v_lshlrev_b32 v132, 16, v202
  v_and_b32 v133, s39, v202
  v_lshlrev_b32 v134, 16, v203
  v_and_b32 v135, s39, v203
  v_pk_mul_f32 v[128:129], v[128:129], s[40:41]
  v_pk_mul_f32 v[130:131], v[130:131], s[40:41]
  v_pk_mul_f32 v[132:133], v[132:133], s[40:41]
  v_pk_mul_f32 v[134:135], v[134:135], s[40:41]
  v_cvt_pk_bf16_f32 v200, v128, v129
  v_cvt_pk_bf16_f32 v201, v130, v131
  v_cvt_pk_bf16_f32 v202, v132, v133
  v_cvt_pk_bf16_f32 v203, v134, v135
  v_lshlrev_b32 v136, 16, v204
  v_and_b32 v137, s39, v204
  v_lshlrev_b32 v138, 16, v205
  v_and_b32 v139, s39, v205
  v_lshlrev_b32 v140, 16, v206
  v_and_b32 v141, s39, v206
  v_lshlrev_b32 v142, 16, v207
  v_and_b32 v143, s39, v207
  v_pk_mul_f32 v[136:137], v[136:137], s[40:41]
  v_pk_mul_f32 v[138:139], v[138:139], s[40:41]
  v_pk_mul_f32 v[140:141], v[140:141], s[40:41]
  v_pk_mul_f32 v[142:143], v[142:143], s[40:41]
  v_cvt_pk_bf16_f32 v204, v136, v137
  v_cvt_pk_bf16_f32 v205, v138, v139
  v_cvt_pk_bf16_f32 v206, v140, v141
  v_cvt_pk_bf16_f32 v207, v142, v143
  v_mfma_f32_16x16x32_bf16 v[16:19], a[128:131], v[192:195], 0
  v_mfma_f32_16x16x32_bf16 v[16:19], a[132:135], v[196:199], v[16:19]
  s_waitcnt lgkmcnt(13)
  v_mfma_f32_16x16x32_bf16 v[16:19], a[136:139], v[200:203], v[16:19]
  s_waitcnt lgkmcnt(12)
  v_mfma_f32_16x16x32_bf16 v[16:19], a[140:143], v[204:207], v[16:19]
  s_waitcnt lgkmcnt(11)
  v_mfma_f32_16x16x32_bf16 v[32:35], a[144:147], v[192:195], 0
  s_waitcnt lgkmcnt(10)
  v_mfma_f32_16x16x32_bf16 v[32:35], a[148:151], v[196:199], v[32:35]
  s_waitcnt lgkmcnt(9)
  v_mfma_f32_16x16x32_bf16 v[32:35], a[152:155], v[200:203], v[32:35]
  s_waitcnt lgkmcnt(8)
  v_mfma_f32_16x16x32_bf16 v[32:35], a[156:159], v[204:207], v[32:35]
  v_max3_f32 v1, v16, v17, v18
  v_max_f32 v1, v1, v19
  s_waitcnt lgkmcnt(7)
  v_mfma_f32_16x16x32_bf16 v[48:51], a[160:163], v[192:195], 0
  v_mov_b32 v5, v1
  s_waitcnt lgkmcnt(6)
  v_mfma_f32_16x16x32_bf16 v[48:51], a[164:167], v[196:199], v[48:51]
  v_permlane16_swap_b32 v1, v5
  v_max_f32 v1, v1, v5
  s_waitcnt lgkmcnt(5)
  v_mfma_f32_16x16x32_bf16 v[48:51], a[168:171], v[200:203], v[48:51]
  v_mov_b32 v5, v1
  s_waitcnt lgkmcnt(4)
  v_mfma_f32_16x16x32_bf16 v[48:51], a[172:175], v[204:207], v[48:51]
  v_permlane32_swap_b32 v1, v5
  v_max_f32 v1, v1, v5
  s_waitcnt lgkmcnt(3)
  v_mfma_f32_16x16x32_bf16 v[64:67], a[176:179], v[192:195], 0
  v_sub_f32 v144, 0x41a00000, v1
  v_sub_f32 v145, 0x41a00000, v1
  s_waitcnt lgkmcnt(2)
  v_mfma_f32_16x16x32_bf16 v[64:67], a[180:183], v[196:199], v[64:67]
  v_sub_f32 v146, 0x41a00000, v1
  v_sub_f32 v147, 0x41a00000, v1
  s_waitcnt lgkmcnt(1)
  v_mfma_f32_16x16x32_bf16 v[64:67], a[184:187], v[200:203], v[64:67]
  s_waitcnt lgkmcnt(0)
  v_mfma_f32_16x16x32_bf16 v[64:67], a[188:191], v[204:207], v[64:67]
  v_pk_add_f32 v[16:17], v[16:17], v[144:145]
  v_pk_add_f32 v[18:19], v[18:19], v[144:145]
  v_pk_add_f32 v[32:33], v[32:33], v[144:145]
  v_pk_add_f32 v[34:35], v[34:35], v[144:145]
  v_pk_add_f32 v[48:49], v[48:49], v[144:145]
  v_pk_add_f32 v[50:51], v[50:51], v[144:145]
  s_nop 1
  v_pk_add_f32 v[64:65], v[64:65], v[144:145]
  v_pk_add_f32 v[66:67], v[66:67], v[144:145]
  v_exp_f32 v16, v16
  v_exp_f32 v17, v17
  v_exp_f32 v18, v18
  v_exp_f32 v19, v19
  v_exp_f32 v32, v32
  v_exp_f32 v33, v33
  v_exp_f32 v34, v34
  v_exp_f32 v35, v35
  v_exp_f32 v48, v48
  v_exp_f32 v49, v49
  v_exp_f32 v50, v50
  v_exp_f32 v51, v51
  v_exp_f32 v64, v64
  v_exp_f32 v65, v65
  v_exp_f32 v66, v66
  v_exp_f32 v67, v67
  v_cvt_pk_bf16_f32 v80, v16, v17
  v_cvt_pk_bf16_f32 v81, v18, v19
  v_cvt_pk_bf16_f32 v82, v32, v33
  v_cvt_pk_bf16_f32 v83, v34, v35
  v_cvt_pk_bf16_f32 v84, v48, v49
  v_cvt_pk_bf16_f32 v85, v50, v51
  v_cvt_pk_bf16_f32 v86, v64, v65
  v_cvt_pk_bf16_f32 v87, v66, v67
  s_waitcnt vmcnt(8)
  ds_read_b128 v[208:211], v12 offset:32768
  ds_read_b128 v[212:215], v13 offset:32768
  ds_read_b128 v[216:219], v14 offset:32768
  ds_read_b128 v[220:223], v15 offset:32768
  s_waitcnt lgkmcnt(3)
  v_lshlrev_b32 v112, 16, v208
  v_and_b32 v113, s39, v208
  v_lshlrev_b32 v114, 16, v209
  v_and_b32 v115, s39, v209
  v_lshlrev_b32 v116, 16, v210
  v_and_b32 v117, s39, v210
  v_lshlrev_b32 v118, 16, v211
  v_and_b32 v119, s39, v211
  v_pk_mul_f32 v[112:113], v[112:113], s[40:41]
  v_pk_mul_f32 v[114:115], v[114:115], s[40:41]
  v_pk_mul_f32 v[116:117], v[116:117], s[40:41]
  v_pk_mul_f32 v[118:119], v[118:119], s[40:41]
  v_cvt_pk_bf16_f32 v208, v112, v113
  v_cvt_pk_bf16_f32 v209, v114, v115
  v_cvt_pk_bf16_f32 v210, v116, v117
  v_cvt_pk_bf16_f32 v211, v118, v119
  s_waitcnt lgkmcnt(2)
  v_lshlrev_b32 v120, 16, v212
  v_and_b32 v121, s39, v212
  v_lshlrev_b32 v122, 16, v213
  v_and_b32 v123, s39, v213
  v_lshlrev_b32 v124, 16, v214
  v_and_b32 v125, s39, v214
  v_lshlrev_b32 v126, 16, v215
  v_and_b32 v127, s39, v215
  v_pk_mul_f32 v[120:121], v[120:121], s[40:41]
  v_pk_mul_f32 v[122:123], v[122:123], s[40:41]
  v_pk_mul_f32 v[124:125], v[124:125], s[40:41]
  v_pk_mul_f32 v[126:127], v[126:127], s[40:41]
  v_cvt_pk_bf16_f32 v212, v120, v121
  v_cvt_pk_bf16_f32 v213, v122, v123
  v_cvt_pk_bf16_f32 v214, v124, v125
  v_cvt_pk_bf16_f32 v215, v126, v127
  s_waitcnt lgkmcnt(1)
  v_lshlrev_b32 v128, 16, v216
  v_and_b32 v129, s39, v216
  v_lshlrev_b32 v130, 16, v217
  v_and_b32 v131, s39, v217
  v_lshlrev_b32 v132, 16, v218
  v_and_b32 v133, s39, v218
  v_lshlrev_b32 v134, 16, v219
  v_and_b32 v135, s39, v219
  v_pk_mul_f32 v[128:129], v[128:129], s[40:41]
  v_pk_mul_f32 v[130:131], v[130:131], s[40:41]
  v_pk_mul_f32 v[132:133], v[132:133], s[40:41]
  v_pk_mul_f32 v[134:135], v[134:135], s[40:41]
  v_cvt_pk_bf16_f32 v216, v128, v129
  v_cvt_pk_bf16_f32 v217, v130, v131
  v_cvt_pk_bf16_f32 v218, v132, v133
  v_cvt_pk_bf16_f32 v219, v134, v135
  s_waitcnt lgkmcnt(0)
  v_lshlrev_b32 v136, 16, v220
  v_and_b32 v137, s39, v220
  v_lshlrev_b32 v138, 16, v221
  v_and_b32 v139, s39, v221
  v_lshlrev_b32 v140, 16, v222
  v_and_b32 v141, s39, v222
  v_lshlrev_b32 v142, 16, v223
  v_and_b32 v143, s39, v223
  v_pk_mul_f32 v[136:137], v[136:137], s[40:41]
  v_pk_mul_f32 v[138:139], v[138:139], s[40:41]
  v_pk_mul_f32 v[140:141], v[140:141], s[40:41]
  v_pk_mul_f32 v[142:143], v[142:143], s[40:41]
  v_cvt_pk_bf16_f32 v220, v136, v137
  v_cvt_pk_bf16_f32 v221, v138, v139
  v_cvt_pk_bf16_f32 v222, v140, v141
  v_cvt_pk_bf16_f32 v223, v142, v143
  v_mfma_f32_16x16x32_bf16 v[20:23], a[128:131], v[208:211], 0
  s_pack_ll_b32_b16 m0, s29, 0
  s_nop 0
  buffer_load_dwordx4 v180, s[16:19], s29 offen offset:0 lds
  v_mfma_f32_16x16x32_bf16 v[20:23], a[132:135], v[212:215], v[20:23]
  buffer_load_dwordx4 v180, s[16:19], s29 offen offset:1024 lds
  v_mfma_f32_16x16x32_bf16 v[20:23], a[136:139], v[216:219], v[20:23]
  buffer_load_dwordx4 v180, s[16:19], s29 offen offset:2048 lds
  v_mfma_f32_16x16x32_bf16 v[20:23], a[140:143], v[220:223], v[20:23]
  buffer_load_dwordx4 v180, s[16:19], s29 offen offset:3072 lds
  v_mfma_f32_16x16x32_bf16 v[36:39], a[144:147], v[208:211], 0
  s_addk_i32 s29, 0x4000
  v_mfma_f32_16x16x32_bf16 v[36:39], a[148:151], v[212:215], v[36:39]
  v_mfma_f32_16x16x32_bf16 v[36:39], a[152:155], v[216:219], v[36:39]
  v_mfma_f32_16x16x32_bf16 v[36:39], a[156:159], v[220:223], v[36:39]
  s_nop 1
  v_max3_f32 v1, v20, v21, v22
  v_max_f32 v1, v1, v23
  v_mfma_f32_16x16x32_bf16 v[52:55], a[160:163], v[208:211], 0
  v_mov_b32 v5, v1
  v_mfma_f32_16x16x32_bf16 v[52:55], a[164:167], v[212:215], v[52:55]
  s_nop 0
  v_permlane16_swap_b32 v1, v5
  v_max_f32 v1, v1, v5
  v_mfma_f32_16x16x32_bf16 v[52:55], a[168:171], v[216:219], v[52:55]
  v_mov_b32 v5, v1
  v_mfma_f32_16x16x32_bf16 v[52:55], a[172:175], v[220:223], v[52:55]
  s_nop 0
  v_permlane32_swap_b32 v1, v5
  v_max_f32 v1, v1, v5
  v_mfma_f32_16x16x32_bf16 v[68:71], a[176:179], v[208:211], 0
  v_sub_f32 v148, 0x41a00000, v1
  v_sub_f32 v149, 0x41a00000, v1
  v_mfma_f32_16x16x32_bf16 v[68:71], a[180:183], v[212:215], v[68:71]
  v_sub_f32 v150, 0x41a00000, v1
  v_sub_f32 v151, 0x41a00000, v1
  v_mfma_f32_16x16x32_bf16 v[68:71], a[184:187], v[216:219], v[68:71]
  v_mfma_f32_16x16x32_bf16 v[68:71], a[188:191], v[220:223], v[68:71]
  v_pk_add_f32 v[20:21], v[20:21], v[148:149]
  v_pk_add_f32 v[22:23], v[22:23], v[148:149]
  v_pk_add_f32 v[36:37], v[36:37], v[148:149]
  v_pk_add_f32 v[38:39], v[38:39], v[148:149]
  v_pk_add_f32 v[52:53], v[52:53], v[148:149]
  v_pk_add_f32 v[54:55], v[54:55], v[148:149]
  s_nop 1
  v_pk_add_f32 v[68:69], v[68:69], v[148:149]
  v_pk_add_f32 v[70:71], v[70:71], v[148:149]
  v_exp_f32 v20, v20
  v_exp_f32 v21, v21
  v_exp_f32 v22, v22
  v_exp_f32 v23, v23
  v_exp_f32 v36, v36
  v_exp_f32 v37, v37
  v_exp_f32 v38, v38
  v_exp_f32 v39, v39
  v_exp_f32 v52, v52
  v_exp_f32 v53, v53
  v_exp_f32 v54, v54
  v_exp_f32 v55, v55
  v_exp_f32 v68, v68
  v_exp_f32 v69, v69
  v_exp_f32 v70, v70
  v_exp_f32 v71, v71
  v_cvt_pk_bf16_f32 v88, v20, v21
  v_cvt_pk_bf16_f32 v89, v22, v23
  v_cvt_pk_bf16_f32 v90, v36, v37
  v_cvt_pk_bf16_f32 v91, v38, v39
  v_cvt_pk_bf16_f32 v92, v52, v53
  v_cvt_pk_bf16_f32 v93, v54, v55
  v_cvt_pk_bf16_f32 v94, v68, v69
  v_cvt_pk_bf16_f32 v95, v70, v71
  s_waitcnt vmcnt(8)
  ds_read_b128 v[224:227], v12 offset:49152
  ds_read_b128 v[228:231], v13 offset:49152
  ds_read_b128 v[232:235], v14 offset:49152
  ds_read_b128 v[236:239], v15 offset:49152
  s_waitcnt lgkmcnt(3)
  v_lshlrev_b32 v112, 16, v224
  v_and_b32 v113, s39, v224
  v_lshlrev_b32 v114, 16, v225
  v_and_b32 v115, s39, v225
  v_lshlrev_b32 v116, 16, v226
  v_and_b32 v117, s39, v226
  v_lshlrev_b32 v118, 16, v227
  v_and_b32 v119, s39, v227
  v_pk_mul_f32 v[112:113], v[112:113], s[40:41]
  v_pk_mul_f32 v[114:115], v[114:115], s[40:41]
  v_pk_mul_f32 v[116:117], v[116:117], s[40:41]
  v_pk_mul_f32 v[118:119], v[118:119], s[40:41]
  v_cvt_pk_bf16_f32 v224, v112, v113
  v_cvt_pk_bf16_f32 v225, v114, v115
  v_cvt_pk_bf16_f32 v226, v116, v117
  v_cvt_pk_bf16_f32 v227, v118, v119
  s_waitcnt lgkmcnt(2)
  v_lshlrev_b32 v120, 16, v228
  v_and_b32 v121, s39, v228
  v_lshlrev_b32 v122, 16, v229
  v_and_b32 v123, s39, v229
  v_lshlrev_b32 v124, 16, v230
  v_and_b32 v125, s39, v230
  v_lshlrev_b32 v126, 16, v231
  v_and_b32 v127, s39, v231
  v_pk_mul_f32 v[120:121], v[120:121], s[40:41]
  v_pk_mul_f32 v[122:123], v[122:123], s[40:41]
  v_pk_mul_f32 v[124:125], v[124:125], s[40:41]
  v_pk_mul_f32 v[126:127], v[126:127], s[40:41]
  v_cvt_pk_bf16_f32 v228, v120, v121
  v_cvt_pk_bf16_f32 v229, v122, v123
  v_cvt_pk_bf16_f32 v230, v124, v125
  v_cvt_pk_bf16_f32 v231, v126, v127
  s_waitcnt lgkmcnt(1)
  v_lshlrev_b32 v128, 16, v232
  v_and_b32 v129, s39, v232
  v_lshlrev_b32 v130, 16, v233
  v_and_b32 v131, s39, v233
  v_lshlrev_b32 v132, 16, v234
  v_and_b32 v133, s39, v234
  v_lshlrev_b32 v134, 16, v235
  v_and_b32 v135, s39, v235
  v_pk_mul_f32 v[128:129], v[128:129], s[40:41]
  v_pk_mul_f32 v[130:131], v[130:131], s[40:41]
  v_pk_mul_f32 v[132:133], v[132:133], s[40:41]
  v_pk_mul_f32 v[134:135], v[134:135], s[40:41]
  v_cvt_pk_bf16_f32 v232, v128, v129
  v_cvt_pk_bf16_f32 v233, v130, v131
  v_cvt_pk_bf16_f32 v234, v132, v133
  v_cvt_pk_bf16_f32 v235, v134, v135
  s_waitcnt lgkmcnt(0)
  v_lshlrev_b32 v136, 16, v236
  v_and_b32 v137, s39, v236
  v_lshlrev_b32 v138, 16, v237
  v_and_b32 v139, s39, v237
  v_lshlrev_b32 v140, 16, v238
  v_and_b32 v141, s39, v238
  v_lshlrev_b32 v142, 16, v239
  v_and_b32 v143, s39, v239
  v_pk_mul_f32 v[136:137], v[136:137], s[40:41]
  v_pk_mul_f32 v[138:139], v[138:139], s[40:41]
  v_pk_mul_f32 v[140:141], v[140:141], s[40:41]
  v_pk_mul_f32 v[142:143], v[142:143], s[40:41]
  v_cvt_pk_bf16_f32 v236, v136, v137
  v_cvt_pk_bf16_f32 v237, v138, v139
  v_cvt_pk_bf16_f32 v238, v140, v141
  v_cvt_pk_bf16_f32 v239, v142, v143
  v_add_u32 v12, 0x4000, v12
  v_add_u32 v13, 0x4000, v13
  v_add_u32 v14, 0x4000, v14
  v_add_u32 v15, 0x4000, v15
  v_mfma_f32_16x16x32_bf16 v[24:27], a[128:131], v[224:227], 0
  s_pack_ll_b32_b16 m0, s30, 1
  s_nop 0
  buffer_load_dwordx4 v181, s[20:23], s30 offen offset:0 lds
  v_mfma_f32_16x16x32_bf16 v[24:27], a[132:135], v[228:231], v[24:27]
  buffer_load_dwordx4 v181, s[20:23], s30 offen offset:1024 lds
  v_mfma_f32_16x16x32_bf16 v[24:27], a[136:139], v[232:235], v[24:27]
  buffer_load_dwordx4 v181, s[20:23], s30 offen offset:2048 lds
  v_mfma_f32_16x16x32_bf16 v[24:27], a[140:143], v[236:239], v[24:27]
  buffer_load_dwordx4 v181, s[20:23], s30 offen offset:3072 lds
  v_mfma_f32_16x16x32_bf16 v[40:43], a[144:147], v[224:227], 0
  s_addk_i32 s30, 0x4000
  v_mfma_f32_16x16x32_bf16 v[40:43], a[148:151], v[228:231], v[40:43]
  v_mfma_f32_16x16x32_bf16 v[40:43], a[152:155], v[232:235], v[40:43]
  v_mfma_f32_16x16x32_bf16 v[40:43], a[156:159], v[236:239], v[40:43]
  s_nop 1
  v_max3_f32 v1, v24, v25, v26
  v_max_f32 v1, v1, v27
  v_mfma_f32_16x16x32_bf16 v[56:59], a[160:163], v[224:227], 0
  v_mov_b32 v5, v1
  v_mfma_f32_16x16x32_bf16 v[56:59], a[164:167], v[228:231], v[56:59]
  s_nop 0
  v_permlane16_swap_b32 v1, v5
  v_max_f32 v1, v1, v5
  v_mfma_f32_16x16x32_bf16 v[56:59], a[168:171], v[232:235], v[56:59]
  v_mov_b32 v5, v1
  v_mfma_f32_16x16x32_bf16 v[56:59], a[172:175], v[236:239], v[56:59]
  s_nop 0
  v_permlane32_swap_b32 v1, v5
  v_max_f32 v1, v1, v5
  v_mfma_f32_16x16x32_bf16 v[72:75], a[176:179], v[224:227], 0
  v_sub_f32 v152, 0x41a00000, v1
  v_sub_f32 v153, 0x41a00000, v1
  v_mfma_f32_16x16x32_bf16 v[72:75], a[180:183], v[228:231], v[72:75]
  v_sub_f32 v154, 0x41a00000, v1
  v_sub_f32 v155, 0x41a00000, v1
  v_mfma_f32_16x16x32_bf16 v[72:75], a[184:187], v[232:235], v[72:75]
  v_mfma_f32_16x16x32_bf16 v[72:75], a[188:191], v[236:239], v[72:75]
  s_waitcnt vmcnt(8)
  ds_read_b128 v[240:243], v12 offset:49152
  ds_read_b128 v[244:247], v13 offset:49152
  ds_read_b128 v[248:251], v14 offset:49152
  ds_read_b128 v[252:255], v15 offset:49152
  v_pk_add_f32 v[24:25], v[24:25], v[152:153]
  v_pk_add_f32 v[26:27], v[26:27], v[152:153]
  v_pk_add_f32 v[40:41], v[40:41], v[152:153]
  v_pk_add_f32 v[42:43], v[42:43], v[152:153]
  v_pk_add_f32 v[56:57], v[56:57], v[152:153]
  v_pk_add_f32 v[58:59], v[58:59], v[152:153]
  v_pk_add_f32 v[72:73], v[72:73], v[152:153]
  v_pk_add_f32 v[74:75], v[74:75], v[152:153]
  v_exp_f32 v24, v24
  v_exp_f32 v25, v25
  v_exp_f32 v26, v26
  v_exp_f32 v27, v27
  v_exp_f32 v40, v40
  v_exp_f32 v41, v41
  v_exp_f32 v42, v42
  v_exp_f32 v43, v43
  v_exp_f32 v56, v56
  s_waitcnt lgkmcnt(3)
  v_lshlrev_b32 v112, 16, v240
  v_and_b32 v113, s39, v240
  v_lshlrev_b32 v114, 16, v241
  v_and_b32 v115, s39, v241
  v_lshlrev_b32 v116, 16, v242
  v_and_b32 v117, s39, v242
  v_lshlrev_b32 v118, 16, v243
  v_and_b32 v119, s39, v243
  v_pk_mul_f32 v[112:113], v[112:113], s[40:41]
  v_pk_mul_f32 v[114:115], v[114:115], s[40:41]
  v_pk_mul_f32 v[116:117], v[116:117], s[40:41]
  v_pk_mul_f32 v[118:119], v[118:119], s[40:41]
  v_cvt_pk_bf16_f32 v240, v112, v113
  v_cvt_pk_bf16_f32 v241, v114, v115
  v_cvt_pk_bf16_f32 v242, v116, v117
  v_cvt_pk_bf16_f32 v243, v118, v119
  s_waitcnt lgkmcnt(2)
  v_lshlrev_b32 v120, 16, v244
  v_and_b32 v121, s39, v244
  v_lshlrev_b32 v122, 16, v245
  v_and_b32 v123, s39, v245
  v_lshlrev_b32 v124, 16, v246
  v_and_b32 v125, s39, v246
  v_lshlrev_b32 v126, 16, v247
  v_and_b32 v127, s39, v247
  v_pk_mul_f32 v[120:121], v[120:121], s[40:41]
  v_pk_mul_f32 v[122:123], v[122:123], s[40:41]
  v_pk_mul_f32 v[124:125], v[124:125], s[40:41]
  v_pk_mul_f32 v[126:127], v[126:127], s[40:41]
  v_cvt_pk_bf16_f32 v244, v120, v121
  v_cvt_pk_bf16_f32 v245, v122, v123
  v_cvt_pk_bf16_f32 v246, v124, v125
  v_cvt_pk_bf16_f32 v247, v126, v127
  s_waitcnt lgkmcnt(1)
  v_lshlrev_b32 v128, 16, v248
  v_and_b32 v129, s39, v248
  v_lshlrev_b32 v130, 16, v249
  v_and_b32 v131, s39, v249
  v_lshlrev_b32 v132, 16, v250
  v_and_b32 v133, s39, v250
  v_lshlrev_b32 v134, 16, v251
  v_and_b32 v135, s39, v251
  v_pk_mul_f32 v[128:129], v[128:129], s[40:41]
  v_pk_mul_f32 v[130:131], v[130:131], s[40:41]
  v_pk_mul_f32 v[132:133], v[132:133], s[40:41]
  v_pk_mul_f32 v[134:135], v[134:135], s[40:41]
  v_cvt_pk_bf16_f32 v248, v128, v129
  v_cvt_pk_bf16_f32 v249, v130, v131
  v_cvt_pk_bf16_f32 v250, v132, v133
  v_cvt_pk_bf16_f32 v251, v134, v135
  s_waitcnt lgkmcnt(0)
  v_lshlrev_b32 v136, 16, v252
  v_and_b32 v137, s39, v252
  v_lshlrev_b32 v138, 16, v253
  v_and_b32 v139, s39, v253
  v_lshlrev_b32 v140, 16, v254
  v_and_b32 v141, s39, v254
  v_lshlrev_b32 v142, 16, v255
  v_and_b32 v143, s39, v255
  v_pk_mul_f32 v[136:137], v[136:137], s[40:41]
  v_pk_mul_f32 v[138:139], v[138:139], s[40:41]
  v_pk_mul_f32 v[140:141], v[140:141], s[40:41]
  v_pk_mul_f32 v[142:143], v[142:143], s[40:41]
  v_cvt_pk_bf16_f32 v252, v136, v137
  v_cvt_pk_bf16_f32 v253, v138, v139
  v_cvt_pk_bf16_f32 v254, v140, v141
  v_cvt_pk_bf16_f32 v255, v142, v143
  v_mfma_f32_16x16x32_bf16 v[28:31], a[128:131], v[240:243], 0
  s_pack_ll_b32_b16 m0, s30, 1
  s_nop 0
  buffer_load_dwordx4 v181, s[20:23], s30 offen offset:0 lds
  v_mfma_f32_16x16x32_bf16 v[28:31], a[132:135], v[244:247], v[28:31]
  buffer_load_dwordx4 v181, s[20:23], s30 offen offset:1024 lds
  v_mfma_f32_16x16x32_bf16 v[28:31], a[136:139], v[248:251], v[28:31]
  buffer_load_dwordx4 v181, s[20:23], s30 offen offset:2048 lds
  v_mfma_f32_16x16x32_bf16 v[28:31], a[140:143], v[252:255], v[28:31]
  buffer_load_dwordx4 v181, s[20:23], s30 offen offset:3072 lds
  v_mfma_f32_16x16x32_bf16 v[44:47], a[144:147], v[240:243], 0
  s_addk_i32 s30, 0x4000
  s_pack_ll_b32_b16 m0, s29, 0
  s_nop 0
  buffer_load_dwordx4 v180, s[16:19], s29 offen offset:0 lds
  v_mfma_f32_16x16x32_bf16 v[44:47], a[148:151], v[244:247], v[44:47]
  buffer_load_dwordx4 v180, s[16:19], s29 offen offset:1024 lds
  v_mfma_f32_16x16x32_bf16 v[44:47], a[152:155], v[248:251], v[44:47]
  buffer_load_dwordx4 v180, s[16:19], s29 offen offset:2048 lds
  v_mfma_f32_16x16x32_bf16 v[44:47], a[156:159], v[252:255], v[44:47]
  v_max3_f32 v1, v28, v29, v30
  v_max_f32 v1, v1, v31
  v_mfma_f32_16x16x32_bf16 v[60:63], a[160:163], v[240:243], 0
  v_mov_b32 v5, v1
  v_mfma_f32_16x16x32_bf16 v[60:63], a[164:167], v[244:247], v[60:63]
  s_nop 0
  v_permlane16_swap_b32 v1, v5
  v_max_f32 v1, v1, v5
  v_mfma_f32_16x16x32_bf16 v[60:63], a[168:171], v[248:251], v[60:63]
  v_mov_b32 v5, v1
  v_mfma_f32_16x16x32_bf16 v[60:63], a[172:175], v[252:255], v[60:63]
  s_nop 0
  v_permlane32_swap_b32 v1, v5
  v_max_f32 v1, v1, v5
  v_mfma_f32_16x16x32_bf16 v[76:79], a[176:179], v[240:243], 0
  v_sub_f32 v156, 0x41a00000, v1
  v_sub_f32 v157, 0x41a00000, v1
  v_mfma_f32_16x16x32_bf16 v[76:79], a[180:183], v[244:247], v[76:79]
  v_sub_f32 v158, 0x41a00000, v1
  v_sub_f32 v159, 0x41a00000, v1
  v_mfma_f32_16x16x32_bf16 v[76:79], a[184:187], v[248:251], v[76:79]
  v_mfma_f32_16x16x32_bf16 v[76:79], a[188:191], v[252:255], v[76:79]
  buffer_load_dwordx4 v180, s[16:19], s29 offen offset:3072 lds
  s_addk_i32 s29, 0x4000
  v_exp_f32 v57, v57
  v_exp_f32 v58, v58
  v_exp_f32 v59, v59
  v_exp_f32 v72, v72
  v_exp_f32 v73, v73
  v_exp_f32 v74, v74
  v_exp_f32 v75, v75
  v_cvt_pk_bf16_f32 v96, v24, v25
  v_cvt_pk_bf16_f32 v97, v26, v27
  v_cvt_pk_bf16_f32 v98, v40, v41
  v_cvt_pk_bf16_f32 v99, v42, v43
  v_cvt_pk_bf16_f32 v100, v56, v57
  v_cvt_pk_bf16_f32 v101, v58, v59
  v_cvt_pk_bf16_f32 v102, v72, v73
  v_cvt_pk_bf16_f32 v103, v74, v75
  s_waitcnt vmcnt(8)
  s_barrier
  ds_read_b128 a[192:195], v168 offset:16384
  ds_read_b128 a[196:199], v169 offset:16384
  ds_read_b128 a[200:203], v170 offset:16384
  ds_read_b128 a[204:207], v171 offset:16384
  v_pk_add_f32 v[28:29], v[28:29], v[156:157]
  v_pk_add_f32 v[30:31], v[30:31], v[156:157]
  v_pk_add_f32 v[44:45], v[44:45], v[156:157]
  v_pk_add_f32 v[46:47], v[46:47], v[156:157]
  v_pk_add_f32 v[60:61], v[60:61], v[156:157]
  v_pk_add_f32 v[62:63], v[62:63], v[156:157]
  v_pk_add_f32 v[76:77], v[76:77], v[156:157]
  v_pk_add_f32 v[78:79], v[78:79], v[156:157]
  v_exp_f32 v28, v28
  v_exp_f32 v29, v29
  v_exp_f32 v30, v30
  v_exp_f32 v31, v31
  v_exp_f32 v44, v44
  v_exp_f32 v45, v45
  v_exp_f32 v46, v46
  v_exp_f32 v47, v47
  v_exp_f32 v60, v60
  v_exp_f32 v61, v61
  v_exp_f32 v62, v62
  v_exp_f32 v63, v63
  v_cvt_pk_bf16_f32 v104, v28, v29
  v_cvt_pk_bf16_f32 v105, v30, v31
  v_cvt_pk_bf16_f32 v106, v44, v45
  v_cvt_pk_bf16_f32 v107, v46, v47
  v_cvt_pk_bf16_f32 v108, v60, v61
  v_cvt_pk_bf16_f32 v109, v62, v63
  s_waitcnt lgkmcnt(0)
L_entry:
  s_cmp_eq_u32 s48, 0
  s_cbranch_scc1 L_loop0
  s_branch L_loop1
.p2align 6
L_loop0:
  v_mfma_f32_16x16x32_bf16 v[16:19], a[192:195], v[192:195], v[144:147]
  v_exp_f32 v76, v76
  v_mfma_f32_16x16x32_bf16 v[16:19], a[196:199], v[196:199], v[16:19]
  ds_read_b128 a[208:211], v168 offset:17408
  v_mfma_f32_16x16x32_bf16 v[16:19], a[200:203], v[200:203], v[16:19]
  v_exp_f32 v77, v77
  v_mfma_f32_16x16x32_bf16 v[16:19], a[204:207], v[204:207], v[16:19]
  ds_read_b128 a[212:215], v169 offset:17408
  v_cvt_pk_bf16_f32 v110, v76, v77
  v_mfma_f32_16x16x32_bf16 v[20:23], a[204:207], v[220:223], v[148:151]
  v_exp_f32 v78, v78
  v_mfma_f32_16x16x32_bf16 v[20:23], a[200:203], v[216:219], v[20:23]
  ds_read_b128 a[216:219], v170 offset:17408
  v_mfma_f32_16x16x32_bf16 v[20:23], a[196:199], v[212:215], v[20:23]
  v_exp_f32 v79, v79
  v_mfma_f32_16x16x32_bf16 v[20:23], a[192:195], v[208:211], v[20:23]
  ds_read_b128 a[220:223], v171 offset:17408
  v_cvt_pk_bf16_f32 v111, v78, v79
  v_mfma_f32_16x16x32_bf16 v[24:27], a[192:195], v[224:227], v[152:155]
  s_pack_ll_b32_b16 m0, s30, 1
  v_exp_f32 v16, v16
  v_mfma_f32_16x16x32_bf16 v[24:27], a[196:199], v[228:231], v[24:27]
  buffer_load_dwordx4 v181, s[20:23], s30 offen offset:0 lds
  v_mfma_f32_16x16x32_bf16 v[24:27], a[200:203], v[232:235], v[24:27]
  v_exp_f32 v17, v17
  v_mfma_f32_16x16x32_bf16 v[24:27], a[204:207], v[236:239], v[24:27]
  ds_read_b64_tr_b16 a[128:129], v172 offset:0
  v_cvt_pk_bf16_f32 v112, v16, v17
  v_mfma_f32_16x16x32_bf16 v[28:31], a[204:207], v[252:255], v[156:159]
  v_exp_f32 v18, v18
  v_mfma_f32_16x16x32_bf16 v[28:31], a[200:203], v[248:251], v[28:31]
  ds_read_b64_tr_b16 a[130:131], v172 offset:1024
  v_mfma_f32_16x16x32_bf16 v[28:31], a[196:199], v[244:247], v[28:31]
  v_exp_f32 v19, v19
  v_mfma_f32_16x16x32_bf16 v[28:31], a[192:195], v[240:243], v[28:31]
  s_waitcnt lgkmcnt(2)
  ds_read_b64_tr_b16 a[132:133], v172 offset:2048
  v_cvt_pk_bf16_f32 v113, v18, v19
  v_mfma_f32_16x16x32_bf16 v[32:35], a[208:211], v[192:195], v[144:147]
  v_exp_f32 v20, v20
  v_mfma_f32_16x16x32_bf16 v[32:35], a[212:215], v[196:199], v[32:35]
  ds_read_b128 a[192:195], v168 offset:18432
  v_mfma_f32_16x16x32_bf16 v[32:35], a[216:219], v[200:203], v[32:35]
  v_exp_f32 v21, v21
  v_mfma_f32_16x16x32_bf16 v[32:35], a[220:223], v[204:207], v[32:35]
  ds_read_b128 a[196:199], v169 offset:18432
  v_cvt_pk_bf16_f32 v120, v20, v21
  v_mfma_f32_16x16x32_bf16 v[36:39], a[220:223], v[220:223], v[148:151]
  v_exp_f32 v22, v22
  v_mfma_f32_16x16x32_bf16 v[36:39], a[216:219], v[216:219], v[36:39]
  ds_read_b128 a[200:203], v170 offset:18432
  v_mfma_f32_16x16x32_bf16 v[36:39], a[212:215], v[212:215], v[36:39]
  v_exp_f32 v23, v23
  v_mfma_f32_16x16x32_bf16 v[36:39], a[208:211], v[208:211], v[36:39]
  ds_read_b128 a[204:207], v171 offset:18432
  v_cvt_pk_bf16_f32 v121, v22, v23
  v_mfma_f32_16x16x32_bf16 v[40:43], a[208:211], v[224:227], v[152:155]
  v_exp_f32 v24, v24
  v_mfma_f32_16x16x32_bf16 v[40:43], a[212:215], v[228:231], v[40:43]
  buffer_load_dwordx4 v181, s[20:23], s30 offen offset:1024 lds
  v_mfma_f32_16x16x32_bf16 v[40:43], a[216:219], v[232:235], v[40:43]
  v_exp_f32 v25, v25
  v_mfma_f32_16x16x32_bf16 v[40:43], a[220:223], v[236:239], v[40:43]
  ds_read_b64_tr_b16 a[134:135], v172 offset:3072
  v_cvt_pk_bf16_f32 v128, v24, v25
  v_mfma_f32_16x16x32_bf16 v[44:47], a[220:223], v[252:255], v[156:159]
  v_exp_f32 v26, v26
  v_mfma_f32_16x16x32_bf16 v[44:47], a[216:219], v[248:251], v[44:47]
  ds_read_b64_tr_b16 a[136:137], v173 offset:0
  v_mfma_f32_16x16x32_bf16 v[44:47], a[212:215], v[244:247], v[44:47]
  v_exp_f32 v27, v27
  v_mfma_f32_16x16x32_bf16 v[44:47], a[208:211], v[240:243], v[44:47]
  s_waitcnt lgkmcnt(2)
  ds_read_b64_tr_b16 a[138:139], v173 offset:1024
  v_cvt_pk_bf16_f32 v129, v26, v27
  v_mfma_f32_16x16x32_bf16 v[48:51], a[192:195], v[192:195], v[144:147]
  v_exp_f32 v28, v28
  v_mfma_f32_16x16x32_bf16 v[48:51], a[196:199], v[196:199], v[48:51]
  ds_read_b128 a[208:211], v168 offset:19456
  v_mfma_f32_16x16x32_bf16 v[48:51], a[200:203], v[200:203], v[48:51]
  v_exp_f32 v29, v29
  v_mfma_f32_16x16x32_bf16 v[48:51], a[204:207], v[204:207], v[48:51]
  ds_read_b128 a[212:215], v169 offset:19456
  v_cvt_pk_bf16_f32 v136, v28, v29
  v_mfma_f32_16x16x32_bf16 v[52:55], a[204:207], v[220:223], v[148:151]
  v_exp_f32 v30, v30
  v_mfma_f32_16x16x32_bf16 v[52:55], a[200:203], v[216:219], v[52:55]
  ds_read_b128 a[216:219], v170 offset:19456
  v_mfma_f32_16x16x32_bf16 v[52:55], a[196:199], v[212:215], v[52:55]
  v_exp_f32 v31, v31
  v_mfma_f32_16x16x32_bf16 v[52:55], a[192:195], v[208:211], v[52:55]
  ds_read_b128 a[220:223], v171 offset:19456
  v_cvt_pk_bf16_f32 v137, v30, v31
  v_mfma_f32_16x16x32_bf16 v[56:59], a[192:195], v[224:227], v[152:155]
  v_exp_f32 v32, v32
  v_mfma_f32_16x16x32_bf16 v[56:59], a[196:199], v[228:231], v[56:59]
  buffer_load_dwordx4 v181, s[20:23], s30 offen offset:2048 lds
  v_mfma_f32_16x16x32_bf16 v[56:59], a[200:203], v[232:235], v[56:59]
  v_exp_f32 v33, v33
  v_mfma_f32_16x16x32_bf16 v[56:59], a[204:207], v[236:239], v[56:59]
  ds_read_b64_tr_b16 a[140:141], v173 offset:2048
  v_cvt_pk_bf16_f32 v114, v32, v33
  v_mfma_f32_16x16x32_bf16 v[60:63], a[204:207], v[252:255], v[156:159]
  v_exp_f32 v34, v34
  v_mfma_f32_16x16x32_bf16 v[60:63], a[200:203], v[248:251], v[60:63]
  v_xor_b32 v168, s33, v168
  v_mfma_f32_16x16x32_bf16 v[60:63], a[196:199], v[244:247], v[60:63]
  v_exp_f32 v35, v35
  v_mfma_f32_16x16x32_bf16 v[60:63], a[192:195], v[240:243], v[60:63]
  s_waitcnt lgkmcnt(1)
  ds_read_b64_tr_b16 a[142:143], v173 offset:3072
  v_cvt_pk_bf16_f32 v115, v34, v35
  v_mfma_f32_16x16x32_bf16 v[64:67], a[208:211], v[192:195], v[144:147]
  v_exp_f32 v36, v36
  v_mfma_f32_16x16x32_bf16 v[64:67], a[212:215], v[196:199], v[64:67]
  ds_read_b64_tr_b16 a[144:145], v174 offset:0
  v_xor_b32 v169, s33, v169
  v_mfma_f32_16x16x32_bf16 v[64:67], a[216:219], v[200:203], v[64:67]
  v_exp_f32 v37, v37
  v_mfma_f32_16x16x32_bf16 v[64:67], a[220:223], v[204:207], v[64:67]
  ds_read_b64_tr_b16 a[146:147], v174 offset:1024
  v_cvt_pk_bf16_f32 v122, v36, v37
  v_mfma_f32_16x16x32_bf16 v[68:71], a[220:223], v[220:223], v[148:151]
  v_exp_f32 v38, v38
  v_mfma_f32_16x16x32_bf16 v[68:71], a[216:219], v[216:219], v[68:71]
  buffer_load_dwordx4 v181, s[20:23], s30 offen offset:3072 lds
  v_mfma_f32_16x16x32_bf16 v[68:71], a[212:215], v[212:215], v[68:71]
  s_addk_i32 s30, 0x4000
  v_exp_f32 v39, v39
  v_mfma_f32_16x16x32_bf16 v[68:71], a[208:211], v[208:211], v[68:71]
  ds_read_b64_tr_b16 a[148:149], v174 offset:2048
  v_cvt_pk_bf16_f32 v123, v38, v39
  v_mfma_f32_16x16x32_bf16 v[72:75], a[208:211], v[224:227], v[152:155]
  v_exp_f32 v40, v40
  v_mfma_f32_16x16x32_bf16 v[72:75], a[212:215], v[228:231], v[72:75]
  ds_read_b64_tr_b16 a[150:151], v174 offset:3072
  v_mfma_f32_16x16x32_bf16 v[72:75], a[216:219], v[232:235], v[72:75]
  v_exp_f32 v41, v41
  v_mfma_f32_16x16x32_bf16 v[72:75], a[220:223], v[236:239], v[72:75]
  ds_read_b64_tr_b16 a[152:153], v175 offset:0
  v_cvt_pk_bf16_f32 v130, v40, v41
  v_mfma_f32_16x16x32_bf16 v[76:79], a[220:223], v[252:255], v[156:159]
  v_exp_f32 v42, v42
  v_mfma_f32_16x16x32_bf16 v[76:79], a[216:219], v[248:251], v[76:79]
  v_xor_b32 v170, s33, v170
  v_mfma_f32_16x16x32_bf16 v[76:79], a[212:215], v[244:247], v[76:79]
  v_exp_f32 v43, v43
  v_mfma_f32_16x16x32_bf16 v[76:79], a[208:211], v[240:243], v[76:79]
  v_exp_f32 v44, v44
  v_smfmac_f32_16x16x64_bf16 a[224:227], a[240:243], v[80:87], v189
  ds_read_b64_tr_b16 a[154:155], v175 offset:1024
  v_smfmac_f32_16x16x64_bf16 a[228:231], a[240:243], v[88:95], v189
  ds_read_b64_tr_b16 a[156:157], v175 offset:2048
  v_smfmac_f32_16x16x64_bf16 a[232:235], a[240:243], v[96:103], v189
  ds_read_b64_tr_b16 a[158:159], v175 offset:3072
  v_smfmac_f32_16x16x64_bf16 a[236:239], a[240:243], v[104:111], v189
  ds_read_b64_tr_b16 a[160:161], v176 offset:0
  v_mfma_f32_16x16x32_bf16 a[0:3], a[128:131], v[80:83], a[0:3]
  s_pack_ll_b32_b16 m0, s29, 0
  v_exp_f32 v45, v45
  v_mfma_f32_16x16x32_bf16 a[0:3], a[132:135], v[84:87], a[0:3]
  buffer_load_dwordx4 v180, s[16:19], s29 offen offset:0 lds
  v_mfma_f32_16x16x32_bf16 a[4:7], a[132:135], v[92:95], a[4:7]
  v_exp_f32 v46, v46
  v_mfma_f32_16x16x32_bf16 a[4:7], a[128:131], v[88:91], a[4:7]
  ds_read_b64_tr_b16 a[162:163], v176 offset:1024
  v_cvt_pk_bf16_f32 v131, v42, v43
  v_mfma_f32_16x16x32_bf16 a[8:11], a[128:131], v[96:99], a[8:11]
  v_exp_f32 v47, v47
  v_mfma_f32_16x16x32_bf16 a[8:11], a[132:135], v[100:103], a[8:11]
  ds_read_b64_tr_b16 a[164:165], v176 offset:2048
  v_cvt_pk_bf16_f32 v138, v44, v45
  v_mfma_f32_16x16x32_bf16 a[12:15], a[132:135], v[108:111], a[12:15]
  v_exp_f32 v48, v48
  v_mfma_f32_16x16x32_bf16 a[12:15], a[128:131], v[104:107], a[12:15]
  s_waitcnt lgkmcnt(11)
  ds_read_b64_tr_b16 a[166:167], v176 offset:3072
  v_cvt_pk_bf16_f32 v139, v46, v47
  v_mfma_f32_16x16x32_bf16 a[16:19], a[136:139], v[80:83], a[16:19]
  v_exp_f32 v49, v49
  v_mfma_f32_16x16x32_bf16 a[16:19], a[140:143], v[84:87], a[16:19]
  v_cvt_pk_bf16_f32 v116, v48, v49
  v_xor_b32 v171, s33, v171
  v_mfma_f32_16x16x32_bf16 a[20:23], a[140:143], v[92:95], a[20:23]
  v_exp_f32 v50, v50
  v_mfma_f32_16x16x32_bf16 a[20:23], a[136:139], v[88:91], a[20:23]
  ds_read_b64_tr_b16 a[168:169], v177 offset:0
  v_mfma_f32_16x16x32_bf16 a[24:27], a[136:139], v[96:99], a[24:27]
  v_exp_f32 v51, v51
  v_mfma_f32_16x16x32_bf16 a[24:27], a[140:143], v[100:103], a[24:27]
  buffer_load_dwordx4 v180, s[16:19], s29 offen offset:1024 lds
  v_mfma_f32_16x16x32_bf16 a[28:31], a[140:143], v[108:111], a[28:31]
  v_exp_f32 v52, v52
  v_mfma_f32_16x16x32_bf16 a[28:31], a[136:139], v[104:107], a[28:31]
  s_waitcnt lgkmcnt(9)
  ds_read_b64_tr_b16 a[170:171], v177 offset:1024
  v_cvt_pk_bf16_f32 v117, v50, v51
  v_mfma_f32_16x16x32_bf16 a[32:35], a[144:147], v[80:83], a[32:35]
  v_exp_f32 v53, v53
  v_mfma_f32_16x16x32_bf16 a[32:35], a[148:151], v[84:87], a[32:35]
  ds_read_b64_tr_b16 a[172:173], v177 offset:2048
  v_cvt_pk_bf16_f32 v124, v52, v53
  v_mfma_f32_16x16x32_bf16 a[36:39], a[148:151], v[92:95], a[36:39]
  v_exp_f32 v54, v54
  v_mfma_f32_16x16x32_bf16 a[36:39], a[144:147], v[88:91], a[36:39]
  ds_read_b64_tr_b16 a[174:175], v177 offset:3072
  v_mfma_f32_16x16x32_bf16 a[40:43], a[144:147], v[96:99], a[40:43]
  v_exp_f32 v55, v55
  v_mfma_f32_16x16x32_bf16 a[40:43], a[148:151], v[100:103], a[40:43]
  ds_read_b64_tr_b16 a[176:177], v178 offset:0
  v_cvt_pk_bf16_f32 v125, v54, v55
  v_mfma_f32_16x16x32_bf16 a[44:47], a[148:151], v[108:111], a[44:47]
  v_exp_f32 v56, v56
  v_mfma_f32_16x16x32_bf16 a[44:47], a[144:147], v[104:107], a[44:47]
  s_waitcnt lgkmcnt(9)
  ds_read_b64_tr_b16 a[178:179], v178 offset:1024
  v_mfma_f32_16x16x32_bf16 a[48:51], a[152:155], v[80:83], a[48:51]
  v_exp_f32 v57, v57
  v_mfma_f32_16x16x32_bf16 a[48:51], a[156:159], v[84:87], a[48:51]
  buffer_load_dwordx4 v180, s[16:19], s29 offen offset:2048 lds
  v_mfma_f32_16x16x32_bf16 a[52:55], a[156:159], v[92:95], a[52:55]
  v_exp_f32 v58, v58
  v_mfma_f32_16x16x32_bf16 a[52:55], a[152:155], v[88:91], a[52:55]
  v_cvt_pk_bf16_f32 v132, v56, v57
  v_mfma_f32_16x16x32_bf16 a[56:59], a[152:155], v[96:99], a[56:59]
  v_exp_f32 v59, v59
  v_mfma_f32_16x16x32_bf16 a[56:59], a[156:159], v[100:103], a[56:59]
  ds_read_b64_tr_b16 a[180:181], v178 offset:2048
  v_cvt_pk_bf16_f32 v133, v58, v59
  v_mfma_f32_16x16x32_bf16 a[60:63], a[156:159], v[108:111], a[60:63]
  v_exp_f32 v60, v60
  v_mfma_f32_16x16x32_bf16 a[60:63], a[152:155], v[104:107], a[60:63]
  s_waitcnt lgkmcnt(7)
  ds_read_b64_tr_b16 a[182:183], v178 offset:3072
  v_mfma_f32_16x16x32_bf16 a[64:67], a[160:163], v[80:83], a[64:67]
  v_exp_f32 v61, v61
  v_mfma_f32_16x16x32_bf16 a[64:67], a[164:167], v[84:87], a[64:67]
  ds_read_b64_tr_b16 a[184:185], v179 offset:0
  v_cvt_pk_bf16_f32 v140, v60, v61
  v_mfma_f32_16x16x32_bf16 a[68:71], a[164:167], v[92:95], a[68:71]
  v_exp_f32 v62, v62
  v_mfma_f32_16x16x32_bf16 a[68:71], a[160:163], v[88:91], a[68:71]
  ds_read_b64_tr_b16 a[186:187], v179 offset:1024
  v_mfma_f32_16x16x32_bf16 a[72:75], a[160:163], v[96:99], a[72:75]
  v_exp_f32 v63, v63
  v_mfma_f32_16x16x32_bf16 a[72:75], a[164:167], v[100:103], a[72:75]
  buffer_load_dwordx4 v180, s[16:19], s29 offen offset:3072 lds
  v_mfma_f32_16x16x32_bf16 a[76:79], a[164:167], v[108:111], a[76:79]
  s_addk_i32 s29, 0x4000
  v_exp_f32 v64, v64
  v_mfma_f32_16x16x32_bf16 a[76:79], a[160:163], v[104:107], a[76:79]
  s_waitcnt lgkmcnt(6)
  ds_read_b64_tr_b16 a[188:189], v179 offset:2048
  v_cvt_pk_bf16_f32 v141, v62, v63
  v_mfma_f32_16x16x32_bf16 a[80:83], a[168:171], v[80:83], a[80:83]
  v_exp_f32 v65, v65
  v_mfma_f32_16x16x32_bf16 a[80:83], a[172:175], v[84:87], a[80:83]
  ds_read_b64_tr_b16 a[190:191], v179 offset:3072
  v_cvt_pk_bf16_f32 v118, v64, v65
  v_mfma_f32_16x16x32_bf16 a[84:87], a[172:175], v[92:95], a[84:87]
  v_exp_f32 v66, v66
  v_mfma_f32_16x16x32_bf16 a[84:87], a[168:171], v[88:91], a[84:87]
  v_mfma_f32_16x16x32_bf16 a[88:91], a[168:171], v[96:99], a[88:91]
  v_exp_f32 v67, v67
  v_mfma_f32_16x16x32_bf16 a[88:91], a[172:175], v[100:103], a[88:91]
  s_waitcnt vmcnt(8)
  v_cvt_pk_bf16_f32 v119, v66, v67
  v_mfma_f32_16x16x32_bf16 a[92:95], a[172:175], v[108:111], a[92:95]
  s_barrier
  v_mfma_f32_16x16x32_bf16 a[92:95], a[168:171], v[104:107], a[92:95]
  s_waitcnt lgkmcnt(4)
  v_exp_f32 v68, v68
  v_mfma_f32_16x16x32_bf16 a[96:99], a[176:179], v[80:83], a[96:99]
  v_mfma_f32_16x16x32_bf16 a[96:99], a[180:183], v[84:87], a[96:99]
  v_exp_f32 v69, v69
  v_mfma_f32_16x16x32_bf16 a[100:103], a[180:183], v[92:95], a[100:103]
  ds_read_b128 a[192:195], v168 offset:0
  v_cvt_pk_bf16_f32 v126, v68, v69
  v_mfma_f32_16x16x32_bf16 a[100:103], a[176:179], v[88:91], a[100:103]
  v_exp_f32 v70, v70
  v_mfma_f32_16x16x32_bf16 a[104:107], a[176:179], v[96:99], a[104:107]
  ds_read_b128 a[196:199], v169 offset:0
  v_mfma_f32_16x16x32_bf16 a[104:107], a[180:183], v[100:103], a[104:107]
  v_exp_f32 v71, v71
  v_mfma_f32_16x16x32_bf16 a[108:111], a[180:183], v[108:111], a[108:111]
  ds_read_b128 a[200:203], v170 offset:0
  v_cvt_pk_bf16_f32 v127, v70, v71
  v_mfma_f32_16x16x32_bf16 a[108:111], a[176:179], v[104:107], a[108:111]
  s_waitcnt lgkmcnt(3)
  v_exp_f32 v72, v72
  v_mfma_f32_16x16x32_bf16 a[112:115], a[184:187], v[80:83], a[112:115]
  ds_read_b128 a[204:207], v171 offset:0
  v_mfma_f32_16x16x32_bf16 a[112:115], a[188:191], v[84:87], a[112:115]
  v_exp_f32 v73, v73
  v_mfma_f32_16x16x32_bf16 a[116:119], a[188:191], v[92:95], a[116:119]
  v_cvt_pk_bf16_f32 v134, v72, v73
  v_mfma_f32_16x16x32_bf16 a[116:119], a[184:187], v[88:91], a[116:119]
  v_exp_f32 v74, v74
  v_mfma_f32_16x16x32_bf16 a[120:123], a[184:187], v[96:99], a[120:123]
  v_mfma_f32_16x16x32_bf16 a[120:123], a[188:191], v[100:103], a[120:123]
  v_exp_f32 v75, v75
  v_mfma_f32_16x16x32_bf16 a[124:127], a[188:191], v[108:111], a[124:127]
  s_waitcnt lgkmcnt(0)
  v_cvt_pk_bf16_f32 v135, v74, v75
  v_mfma_f32_16x16x32_bf16 a[124:127], a[184:187], v[104:107], a[124:127]
  v_mfma_f32_16x16x32_bf16 v[16:19], a[192:195], v[192:195], v[144:147]
  v_exp_f32 v76, v76
  v_mfma_f32_16x16x32_bf16 v[16:19], a[196:199], v[196:199], v[16:19]
  ds_read_b128 a[208:211], v168 offset:1024
  v_mfma_f32_16x16x32_bf16 v[16:19], a[200:203], v[200:203], v[16:19]
  v_exp_f32 v77, v77
  v_mfma_f32_16x16x32_bf16 v[16:19], a[204:207], v[204:207], v[16:19]
  ds_read_b128 a[212:215], v169 offset:1024
  v_cvt_pk_bf16_f32 v142, v76, v77
  v_mfma_f32_16x16x32_bf16 v[20:23], a[204:207], v[220:223], v[148:151]
  v_exp_f32 v78, v78
  v_mfma_f32_16x16x32_bf16 v[20:23], a[200:203], v[216:219], v[20:23]
  ds_read_b128 a[216:219], v170 offset:1024
  v_mfma_f32_16x16x32_bf16 v[20:23], a[196:199], v[212:215], v[20:23]
  v_exp_f32 v79, v79
  v_mfma_f32_16x16x32_bf16 v[20:23], a[192:195], v[208:211], v[20:23]
  ds_read_b128 a[220:223], v171 offset:1024
  v_cvt_pk_bf16_f32 v143, v78, v79
  v_mfma_f32_16x16x32_bf16 v[24:27], a[192:195], v[224:227], v[152:155]
  s_pack_ll_b32_b16 m0, s30, 1
  v_exp_f32 v16, v16
  v_mfma_f32_16x16x32_bf16 v[24:27], a[196:199], v[228:231], v[24:27]
  buffer_load_dwordx4 v181, s[20:23], s30 offen offset:0 lds
  v_mfma_f32_16x16x32_bf16 v[24:27], a[200:203], v[232:235], v[24:27]
  v_exp_f32 v17, v17
  v_mfma_f32_16x16x32_bf16 v[24:27], a[204:207], v[236:239], v[24:27]
  ds_read_b64_tr_b16 a[128:129], v172 offset:16384
  v_cvt_pk_bf16_f32 v80, v16, v17
  v_mfma_f32_16x16x32_bf16 v[28:31], a[204:207], v[252:255], v[156:159]
  v_exp_f32 v18, v18
  v_mfma_f32_16x16x32_bf16 v[28:31], a[200:203], v[248:251], v[28:31]
  ds_read_b64_tr_b16 a[130:131], v172 offset:17408
  v_mfma_f32_16x16x32_bf16 v[28:31], a[196:199], v[244:247], v[28:31]
  v_exp_f32 v19, v19
  v_mfma_f32_16x16x32_bf16 v[28:31], a[192:195], v[240:243], v[28:31]
  s_waitcnt lgkmcnt(2)
  ds_read_b64_tr_b16 a[132:133], v172 offset:18432
  v_cvt_pk_bf16_f32 v81, v18, v19
  v_mfma_f32_16x16x32_bf16 v[32:35], a[208:211], v[192:195], v[144:147]
  v_exp_f32 v20, v20
  v_mfma_f32_16x16x32_bf16 v[32:35], a[212:215], v[196:199], v[32:35]
  ds_read_b128 a[192:195], v168 offset:2048
  v_mfma_f32_16x16x32_bf16 v[32:35], a[216:219], v[200:203], v[32:35]
  v_exp_f32 v21, v21
  v_mfma_f32_16x16x32_bf16 v[32:35], a[220:223], v[204:207], v[32:35]
  ds_read_b128 a[196:199], v169 offset:2048
  v_cvt_pk_bf16_f32 v88, v20, v21
  v_mfma_f32_16x16x32_bf16 v[36:39], a[220:223], v[220:223], v[148:151]
  v_exp_f32 v22, v22
  v_mfma_f32_16x16x32_bf16 v[36:39], a[216:219], v[216:219], v[36:39]
  ds_read_b128 a[200:203], v170 offset:2048
  v_mfma_f32_16x16x32_bf16 v[36:39], a[212:215], v[212:215], v[36:39]
  v_exp_f32 v23, v23
  v_mfma_f32_16x16x32_bf16 v[36:39], a[208:211], v[208:211], v[36:39]
  ds_read_b128 a[204:207], v171 offset:2048
  v_cvt_pk_bf16_f32 v89, v22, v23
  v_mfma_f32_16x16x32_bf16 v[40:43], a[208:211], v[224:227], v[152:155]
  v_exp_f32 v24, v24
  v_mfma_f32_16x16x32_bf16 v[40:43], a[212:215], v[228:231], v[40:43]
  buffer_load_dwordx4 v181, s[20:23], s30 offen offset:1024 lds
  v_mfma_f32_16x16x32_bf16 v[40:43], a[216:219], v[232:235], v[40:43]
  v_exp_f32 v25, v25
  v_mfma_f32_16x16x32_bf16 v[40:43], a[220:223], v[236:239], v[40:43]
  ds_read_b64_tr_b16 a[134:135], v172 offset:19456
  v_cvt_pk_bf16_f32 v96, v24, v25
  v_mfma_f32_16x16x32_bf16 v[44:47], a[220:223], v[252:255], v[156:159]
  v_exp_f32 v26, v26
  v_mfma_f32_16x16x32_bf16 v[44:47], a[216:219], v[248:251], v[44:47]
  ds_read_b64_tr_b16 a[136:137], v173 offset:16384
  v_mfma_f32_16x16x32_bf16 v[44:47], a[212:215], v[244:247], v[44:47]
  v_exp_f32 v27, v27
  v_mfma_f32_16x16x32_bf16 v[44:47], a[208:211], v[240:243], v[44:47]
  s_waitcnt lgkmcnt(2)
  ds_read_b64_tr_b16 a[138:139], v173 offset:17408
  v_cvt_pk_bf16_f32 v97, v26, v27
  v_mfma_f32_16x16x32_bf16 v[48:51], a[192:195], v[192:195], v[144:147]
  v_exp_f32 v28, v28
  v_mfma_f32_16x16x32_bf16 v[48:51], a[196:199], v[196:199], v[48:51]
  ds_read_b128 a[208:211], v168 offset:3072
  v_mfma_f32_16x16x32_bf16 v[48:51], a[200:203], v[200:203], v[48:51]
  v_exp_f32 v29, v29
  v_mfma_f32_16x16x32_bf16 v[48:51], a[204:207], v[204:207], v[48:51]
  ds_read_b128 a[212:215], v169 offset:3072
  v_cvt_pk_bf16_f32 v104, v28, v29
  v_mfma_f32_16x16x32_bf16 v[52:55], a[204:207], v[220:223], v[148:151]
  v_exp_f32 v30, v30
  v_mfma_f32_16x16x32_bf16 v[52:55], a[200:203], v[216:219], v[52:55]
  ds_read_b128 a[216:219], v170 offset:3072
  v_mfma_f32_16x16x32_bf16 v[52:55], a[196:199], v[212:215], v[52:55]
  v_exp_f32 v31, v31
  v_mfma_f32_16x16x32_bf16 v[52:55], a[192:195], v[208:211], v[52:55]
  ds_read_b128 a[220:223], v171 offset:3072
  v_cvt_pk_bf16_f32 v105, v30, v31
  v_mfma_f32_16x16x32_bf16 v[56:59], a[192:195], v[224:227], v[152:155]
  v_exp_f32 v32, v32
  v_mfma_f32_16x16x32_bf16 v[56:59], a[196:199], v[228:231], v[56:59]
  buffer_load_dwordx4 v181, s[20:23], s30 offen offset:2048 lds
  v_mfma_f32_16x16x32_bf16 v[56:59], a[200:203], v[232:235], v[56:59]
  v_exp_f32 v33, v33
  v_mfma_f32_16x16x32_bf16 v[56:59], a[204:207], v[236:239], v[56:59]
  ds_read_b64_tr_b16 a[140:141], v173 offset:18432
  v_cvt_pk_bf16_f32 v82, v32, v33
  v_mfma_f32_16x16x32_bf16 v[60:63], a[204:207], v[252:255], v[156:159]
  v_exp_f32 v34, v34
  v_mfma_f32_16x16x32_bf16 v[60:63], a[200:203], v[248:251], v[60:63]
  v_xor_b32 v172, s33, v172
  v_mfma_f32_16x16x32_bf16 v[60:63], a[196:199], v[244:247], v[60:63]
  v_exp_f32 v35, v35
  v_mfma_f32_16x16x32_bf16 v[60:63], a[192:195], v[240:243], v[60:63]
  s_waitcnt lgkmcnt(1)
  ds_read_b64_tr_b16 a[142:143], v173 offset:19456
  v_cvt_pk_bf16_f32 v83, v34, v35
  v_mfma_f32_16x16x32_bf16 v[64:67], a[208:211], v[192:195], v[144:147]
  v_exp_f32 v36, v36
  v_mfma_f32_16x16x32_bf16 v[64:67], a[212:215], v[196:199], v[64:67]
  ds_read_b64_tr_b16 a[144:145], v174 offset:16384
  v_xor_b32 v173, s33, v173
  v_mfma_f32_16x16x32_bf16 v[64:67], a[216:219], v[200:203], v[64:67]
  v_exp_f32 v37, v37
  v_mfma_f32_16x16x32_bf16 v[64:67], a[220:223], v[204:207], v[64:67]
  ds_read_b64_tr_b16 a[146:147], v174 offset:17408
  v_cvt_pk_bf16_f32 v90, v36, v37
  v_mfma_f32_16x16x32_bf16 v[68:71], a[220:223], v[220:223], v[148:151]
  v_exp_f32 v38, v38
  v_mfma_f32_16x16x32_bf16 v[68:71], a[216:219], v[216:219], v[68:71]
  buffer_load_dwordx4 v181, s[20:23], s30 offen offset:3072 lds
  v_mfma_f32_16x16x32_bf16 v[68:71], a[212:215], v[212:215], v[68:71]
  s_addk_i32 s30, 0x4000
  v_exp_f32 v39, v39
  v_mfma_f32_16x16x32_bf16 v[68:71], a[208:211], v[208:211], v[68:71]
  ds_read_b64_tr_b16 a[148:149], v174 offset:18432
  v_cvt_pk_bf16_f32 v91, v38, v39
  v_mfma_f32_16x16x32_bf16 v[72:75], a[208:211], v[224:227], v[152:155]
  v_exp_f32 v40, v40
  v_mfma_f32_16x16x32_bf16 v[72:75], a[212:215], v[228:231], v[72:75]
  ds_read_b64_tr_b16 a[150:151], v174 offset:19456
  v_mfma_f32_16x16x32_bf16 v[72:75], a[216:219], v[232:235], v[72:75]
  v_exp_f32 v41, v41
  v_mfma_f32_16x16x32_bf16 v[72:75], a[220:223], v[236:239], v[72:75]
  ds_read_b64_tr_b16 a[152:153], v175 offset:16384
  v_cvt_pk_bf16_f32 v98, v40, v41
  v_mfma_f32_16x16x32_bf16 v[76:79], a[220:223], v[252:255], v[156:159]
  v_exp_f32 v42, v42
  v_mfma_f32_16x16x32_bf16 v[76:79], a[216:219], v[248:251], v[76:79]
  v_xor_b32 v174, s33, v174
  v_mfma_f32_16x16x32_bf16 v[76:79], a[212:215], v[244:247], v[76:79]
  v_exp_f32 v43, v43
  v_mfma_f32_16x16x32_bf16 v[76:79], a[208:211], v[240:243], v[76:79]
  v_exp_f32 v44, v44
  v_smfmac_f32_16x16x64_bf16 a[224:227], a[240:243], v[112:119], v189
  ds_read_b64_tr_b16 a[154:155], v175 offset:17408
  v_smfmac_f32_16x16x64_bf16 a[228:231], a[240:243], v[120:127], v189
  ds_read_b64_tr_b16 a[156:157], v175 offset:18432
  v_smfmac_f32_16x16x64_bf16 a[232:235], a[240:243], v[128:135], v189
  ds_read_b64_tr_b16 a[158:159], v175 offset:19456
  v_smfmac_f32_16x16x64_bf16 a[236:239], a[240:243], v[136:143], v189
  ds_read_b64_tr_b16 a[160:161], v176 offset:16384
  v_mfma_f32_16x16x32_bf16 a[0:3], a[128:131], v[112:115], a[0:3]
  s_pack_ll_b32_b16 m0, s29, 0
  v_exp_f32 v45, v45
  v_mfma_f32_16x16x32_bf16 a[0:3], a[132:135], v[116:119], a[0:3]
  buffer_load_dwordx4 v180, s[16:19], s29 offen offset:0 lds
  v_mfma_f32_16x16x32_bf16 a[4:7], a[132:135], v[124:127], a[4:7]
  v_exp_f32 v46, v46
  v_mfma_f32_16x16x32_bf16 a[4:7], a[128:131], v[120:123], a[4:7]
  ds_read_b64_tr_b16 a[162:163], v176 offset:17408
  v_cvt_pk_bf16_f32 v99, v42, v43
  v_mfma_f32_16x16x32_bf16 a[8:11], a[128:131], v[128:131], a[8:11]
  v_exp_f32 v47, v47
  v_mfma_f32_16x16x32_bf16 a[8:11], a[132:135], v[132:135], a[8:11]
  ds_read_b64_tr_b16 a[164:165], v176 offset:18432
  v_cvt_pk_bf16_f32 v106, v44, v45
  v_mfma_f32_16x16x32_bf16 a[12:15], a[132:135], v[140:143], a[12:15]
  v_exp_f32 v48, v48
  v_mfma_f32_16x16x32_bf16 a[12:15], a[128:131], v[136:139], a[12:15]
  s_waitcnt lgkmcnt(11)
  ds_read_b64_tr_b16 a[166:167], v176 offset:19456
  v_cvt_pk_bf16_f32 v107, v46, v47
  v_mfma_f32_16x16x32_bf16 a[16:19], a[136:139], v[112:115], a[16:19]
  v_exp_f32 v49, v49
  v_mfma_f32_16x16x32_bf16 a[16:19], a[140:143], v[116:119], a[16:19]
  v_cvt_pk_bf16_f32 v84, v48, v49
  v_xor_b32 v175, s33, v175
  v_mfma_f32_16x16x32_bf16 a[20:23], a[140:143], v[124:127], a[20:23]
  v_exp_f32 v50, v50
  v_mfma_f32_16x16x32_bf16 a[20:23], a[136:139], v[120:123], a[20:23]
  ds_read_b64_tr_b16 a[168:169], v177 offset:16384
  v_xor_b32 v176, s33, v176
  v_mfma_f32_16x16x32_bf16 a[24:27], a[136:139], v[128:131], a[24:27]
  v_exp_f32 v51, v51
  v_mfma_f32_16x16x32_bf16 a[24:27], a[140:143], v[132:135], a[24:27]
  buffer_load_dwordx4 v180, s[16:19], s29 offen offset:1024 lds
  v_mfma_f32_16x16x32_bf16 a[28:31], a[140:143], v[140:143], a[28:31]
  v_exp_f32 v52, v52
  v_mfma_f32_16x16x32_bf16 a[28:31], a[136:139], v[136:139], a[28:31]
  s_waitcnt lgkmcnt(9)
  ds_read_b64_tr_b16 a[170:171], v177 offset:17408
  v_cvt_pk_bf16_f32 v85, v50, v51
  v_mfma_f32_16x16x32_bf16 a[32:35], a[144:147], v[112:115], a[32:35]
  v_exp_f32 v53, v53
  v_mfma_f32_16x16x32_bf16 a[32:35], a[148:151], v[116:119], a[32:35]
  ds_read_b64_tr_b16 a[172:173], v177 offset:18432
  v_cvt_pk_bf16_f32 v92, v52, v53
  v_mfma_f32_16x16x32_bf16 a[36:39], a[148:151], v[124:127], a[36:39]
  v_exp_f32 v54, v54
  v_mfma_f32_16x16x32_bf16 a[36:39], a[144:147], v[120:123], a[36:39]
  ds_read_b64_tr_b16 a[174:175], v177 offset:19456
  v_mfma_f32_16x16x32_bf16 a[40:43], a[144:147], v[128:131], a[40:43]
  v_exp_f32 v55, v55
  v_mfma_f32_16x16x32_bf16 a[40:43], a[148:151], v[132:135], a[40:43]
  ds_read_b64_tr_b16 a[176:177], v178 offset:16384
  v_cvt_pk_bf16_f32 v93, v54, v55
  v_mfma_f32_16x16x32_bf16 a[44:47], a[148:151], v[140:143], a[44:47]
  v_exp_f32 v56, v56
  v_mfma_f32_16x16x32_bf16 a[44:47], a[144:147], v[136:139], a[44:47]
  s_waitcnt lgkmcnt(9)
  ds_read_b64_tr_b16 a[178:179], v178 offset:17408
  v_xor_b32 v177, s33, v177
  v_mfma_f32_16x16x32_bf16 a[48:51], a[152:155], v[112:115], a[48:51]
  v_exp_f32 v57, v57
  v_mfma_f32_16x16x32_bf16 a[48:51], a[156:159], v[116:119], a[48:51]
  buffer_load_dwordx4 v180, s[16:19], s29 offen offset:2048 lds
  v_mfma_f32_16x16x32_bf16 a[52:55], a[156:159], v[124:127], a[52:55]
  v_exp_f32 v58, v58
  v_mfma_f32_16x16x32_bf16 a[52:55], a[152:155], v[120:123], a[52:55]
  v_cvt_pk_bf16_f32 v100, v56, v57
  v_mfma_f32_16x16x32_bf16 a[56:59], a[152:155], v[128:131], a[56:59]
  v_exp_f32 v59, v59
  v_mfma_f32_16x16x32_bf16 a[56:59], a[156:159], v[132:135], a[56:59]
  ds_read_b64_tr_b16 a[180:181], v178 offset:18432
  v_cvt_pk_bf16_f32 v101, v58, v59
  v_mfma_f32_16x16x32_bf16 a[60:63], a[156:159], v[140:143], a[60:63]
  v_exp_f32 v60, v60
  v_mfma_f32_16x16x32_bf16 a[60:63], a[152:155], v[136:139], a[60:63]
  s_waitcnt lgkmcnt(7)
  ds_read_b64_tr_b16 a[182:183], v178 offset:19456
  v_mfma_f32_16x16x32_bf16 a[64:67], a[160:163], v[112:115], a[64:67]
  v_exp_f32 v61, v61
  v_mfma_f32_16x16x32_bf16 a[64:67], a[164:167], v[116:119], a[64:67]
  ds_read_b64_tr_b16 a[184:185], v179 offset:16384
  v_cvt_pk_bf16_f32 v108, v60, v61
  v_mfma_f32_16x16x32_bf16 a[68:71], a[164:167], v[124:127], a[68:71]
  v_exp_f32 v62, v62
  v_mfma_f32_16x16x32_bf16 a[68:71], a[160:163], v[120:123], a[68:71]
  ds_read_b64_tr_b16 a[186:187], v179 offset:17408
  v_xor_b32 v178, s33, v178
  v_mfma_f32_16x16x32_bf16 a[72:75], a[160:163], v[128:131], a[72:75]
  v_exp_f32 v63, v63
  v_mfma_f32_16x16x32_bf16 a[72:75], a[164:167], v[132:135], a[72:75]
  buffer_load_dwordx4 v180, s[16:19], s29 offen offset:3072 lds
  v_mfma_f32_16x16x32_bf16 a[76:79], a[164:167], v[140:143], a[76:79]
  s_addk_i32 s29, 0x4000
  v_exp_f32 v64, v64
  v_mfma_f32_16x16x32_bf16 a[76:79], a[160:163], v[136:139], a[76:79]
  s_waitcnt lgkmcnt(6)
  ds_read_b64_tr_b16 a[188:189], v179 offset:18432
  v_cvt_pk_bf16_f32 v109, v62, v63
  v_mfma_f32_16x16x32_bf16 a[80:83], a[168:171], v[112:115], a[80:83]
  v_exp_f32 v65, v65
  v_mfma_f32_16x16x32_bf16 a[80:83], a[172:175], v[116:119], a[80:83]
  ds_read_b64_tr_b16 a[190:191], v179 offset:19456
  v_cvt_pk_bf16_f32 v86, v64, v65
  v_mfma_f32_16x16x32_bf16 a[84:87], a[172:175], v[124:127], a[84:87]
  v_exp_f32 v66, v66
  v_mfma_f32_16x16x32_bf16 a[84:87], a[168:171], v[120:123], a[84:87]
  v_xor_b32 v179, s33, v179
  v_mfma_f32_16x16x32_bf16 a[88:91], a[168:171], v[128:131], a[88:91]
  v_exp_f32 v67, v67
  v_mfma_f32_16x16x32_bf16 a[88:91], a[172:175], v[132:135], a[88:91]
  s_waitcnt vmcnt(8)
  v_cvt_pk_bf16_f32 v87, v66, v67
  v_mfma_f32_16x16x32_bf16 a[92:95], a[172:175], v[140:143], a[92:95]
  s_barrier
  v_mfma_f32_16x16x32_bf16 a[92:95], a[168:171], v[136:139], a[92:95]
  s_waitcnt lgkmcnt(4)
  v_exp_f32 v68, v68
  v_mfma_f32_16x16x32_bf16 a[96:99], a[176:179], v[112:115], a[96:99]
  v_mfma_f32_16x16x32_bf16 a[96:99], a[180:183], v[116:119], a[96:99]
  v_exp_f32 v69, v69
  v_mfma_f32_16x16x32_bf16 a[100:103], a[180:183], v[124:127], a[100:103]
  ds_read_b128 a[192:195], v168 offset:16384
  v_cvt_pk_bf16_f32 v94, v68, v69
  v_mfma_f32_16x16x32_bf16 a[100:103], a[176:179], v[120:123], a[100:103]
  v_exp_f32 v70, v70
  v_mfma_f32_16x16x32_bf16 a[104:107], a[176:179], v[128:131], a[104:107]
  ds_read_b128 a[196:199], v169 offset:16384
  v_mfma_f32_16x16x32_bf16 a[104:107], a[180:183], v[132:135], a[104:107]
  v_exp_f32 v71, v71
  v_mfma_f32_16x16x32_bf16 a[108:111], a[180:183], v[140:143], a[108:111]
  ds_read_b128 a[200:203], v170 offset:16384
  v_cvt_pk_bf16_f32 v95, v70, v71
  v_mfma_f32_16x16x32_bf16 a[108:111], a[176:179], v[136:139], a[108:111]
  s_waitcnt lgkmcnt(3)
  v_exp_f32 v72, v72
  v_mfma_f32_16x16x32_bf16 a[112:115], a[184:187], v[112:115], a[112:115]
  ds_read_b128 a[204:207], v171 offset:16384
  v_mfma_f32_16x16x32_bf16 a[112:115], a[188:191], v[116:119], a[112:115]
  v_exp_f32 v73, v73
  v_mfma_f32_16x16x32_bf16 a[116:119], a[188:191], v[124:127], a[116:119]
  v_cvt_pk_bf16_f32 v102, v72, v73
  v_mfma_f32_16x16x32_bf16 a[116:119], a[184:187], v[120:123], a[116:119]
  v_exp_f32 v74, v74
  v_mfma_f32_16x16x32_bf16 a[120:123], a[184:187], v[128:131], a[120:123]
  s_sub_u32 s31, s31, 1
  v_mfma_f32_16x16x32_bf16 a[120:123], a[188:191], v[132:135], a[120:123]
  s_cmp_lg_u32 s31, 0
  v_exp_f32 v75, v75
  v_mfma_f32_16x16x32_bf16 a[124:127], a[188:191], v[140:143], a[124:127]
  s_waitcnt lgkmcnt(0)
  v_cvt_pk_bf16_f32 v103, v74, v75
  v_mfma_f32_16x16x32_bf16 a[124:127], a[184:187], v[136:139], a[124:127]
  s_cbranch_scc1 L_loop0
  s_branch L_tail
.p2align 6
L_loop1:
  v_mfma_f32_16x16x32_bf16 v[16:19], a[192:195], v[192:195], v[144:147]
  v_exp_f32 v76, v76
  v_mfma_f32_16x16x32_bf16 v[16:19], a[196:199], v[196:199], v[16:19]
  ds_read_b128 a[208:211], v168 offset:17408
  v_mfma_f32_16x16x32_bf16 v[16:19], a[200:203], v[200:203], v[16:19]
  v_exp_f32 v77, v77
  v_mfma_f32_16x16x32_bf16 v[16:19], a[204:207], v[204:207], v[16:19]
  ds_read_b128 a[212:215], v169 offset:17408
  v_cvt_pk_bf16_f32 v110, v76, v77
  v_mfma_f32_16x16x32_bf16 v[20:23], a[204:207], v[220:223], v[148:151]
  v_exp_f32 v78, v78
  v_mfma_f32_16x16x32_bf16 v[20:23], a[200:203], v[216:219], v[20:23]
  ds_read_b128 a[216:219], v170 offset:17408
  v_mfma_f32_16x16x32_bf16 v[20:23], a[196:199], v[212:215], v[20:23]
  v_exp_f32 v79, v79
  v_mfma_f32_16x16x32_bf16 v[20:23], a[192:195], v[208:211], v[20:23]
  ds_read_b128 a[220:223], v171 offset:17408
  v_cvt_pk_bf16_f32 v111, v78, v79
  v_mfma_f32_16x16x32_bf16 v[24:27], a[192:195], v[224:227], v[152:155]
  v_exp_f32 v16, v16
  v_mfma_f32_16x16x32_bf16 v[24:27], a[196:199], v[228:231], v[24:27]
  ds_read_b64_tr_b16 a[128:129], v172 offset:0
  v_mfma_f32_16x16x32_bf16 v[24:27], a[200:203], v[232:235], v[24:27]
  v_exp_f32 v17, v17
  v_mfma_f32_16x16x32_bf16 v[24:27], a[204:207], v[236:239], v[24:27]
  ds_read_b64_tr_b16 a[130:131], v172 offset:1024
  v_cvt_pk_bf16_f32 v112, v16, v17
  v_mfma_f32_16x16x32_bf16 v[28:31], a[204:207], v[252:255], v[156:159]
  s_pack_ll_b32_b16 m0, s30, 1
  v_exp_f32 v18, v18
  v_mfma_f32_16x16x32_bf16 v[28:31], a[200:203], v[248:251], v[28:31]
  buffer_load_dwordx4 v181, s[20:23], s30 offen offset:0 lds
  v_mfma_f32_16x16x32_bf16 v[28:31], a[196:199], v[244:247], v[28:31]
  v_exp_f32 v19, v19
  v_mfma_f32_16x16x32_bf16 v[28:31], a[192:195], v[240:243], v[28:31]
  s_waitcnt lgkmcnt(2)
  ds_read_b64_tr_b16 a[132:133], v172 offset:2048
  v_cvt_pk_bf16_f32 v113, v18, v19
  v_mfma_f32_16x16x32_bf16 v[32:35], a[208:211], v[192:195], v[144:147]
  v_exp_f32 v20, v20
  v_mfma_f32_16x16x32_bf16 v[32:35], a[212:215], v[196:199], v[32:35]
  ds_read_b128 a[192:195], v168 offset:18432
  v_mfma_f32_16x16x32_bf16 v[32:35], a[216:219], v[200:203], v[32:35]
  v_exp_f32 v21, v21
  v_mfma_f32_16x16x32_bf16 v[32:35], a[220:223], v[204:207], v[32:35]
  ds_read_b128 a[196:199], v169 offset:18432
  v_cvt_pk_bf16_f32 v120, v20, v21
  v_mfma_f32_16x16x32_bf16 v[36:39], a[220:223], v[220:223], v[148:151]
  v_exp_f32 v22, v22
  v_mfma_f32_16x16x32_bf16 v[36:39], a[216:219], v[216:219], v[36:39]
  ds_read_b128 a[200:203], v170 offset:18432
  v_mfma_f32_16x16x32_bf16 v[36:39], a[212:215], v[212:215], v[36:39]
  v_exp_f32 v23, v23
  v_mfma_f32_16x16x32_bf16 v[36:39], a[208:211], v[208:211], v[36:39]
  ds_read_b128 a[204:207], v171 offset:18432
  v_cvt_pk_bf16_f32 v121, v22, v23
  v_mfma_f32_16x16x32_bf16 v[40:43], a[208:211], v[224:227], v[152:155]
  v_exp_f32 v24, v24
  v_mfma_f32_16x16x32_bf16 v[40:43], a[212:215], v[228:231], v[40:43]
  ds_read_b64_tr_b16 a[134:135], v172 offset:3072
  v_mfma_f32_16x16x32_bf16 v[40:43], a[216:219], v[232:235], v[40:43]
  v_exp_f32 v25, v25
  v_mfma_f32_16x16x32_bf16 v[40:43], a[220:223], v[236:239], v[40:43]
  ds_read_b64_tr_b16 a[136:137], v173 offset:0
  v_cvt_pk_bf16_f32 v128, v24, v25
  v_mfma_f32_16x16x32_bf16 v[44:47], a[220:223], v[252:255], v[156:159]
  v_exp_f32 v26, v26
  v_mfma_f32_16x16x32_bf16 v[44:47], a[216:219], v[248:251], v[44:47]
  buffer_load_dwordx4 v181, s[20:23], s30 offen offset:1024 lds
  v_mfma_f32_16x16x32_bf16 v[44:47], a[212:215], v[244:247], v[44:47]
  v_exp_f32 v27, v27
  v_mfma_f32_16x16x32_bf16 v[44:47], a[208:211], v[240:243], v[44:47]
  s_waitcnt lgkmcnt(2)
  ds_read_b64_tr_b16 a[138:139], v173 offset:1024
  v_cvt_pk_bf16_f32 v129, v26, v27
  v_mfma_f32_16x16x32_bf16 v[48:51], a[192:195], v[192:195], v[144:147]
  v_exp_f32 v28, v28
  v_mfma_f32_16x16x32_bf16 v[48:51], a[196:199], v[196:199], v[48:51]
  ds_read_b128 a[208:211], v168 offset:19456
  v_mfma_f32_16x16x32_bf16 v[48:51], a[200:203], v[200:203], v[48:51]
  v_exp_f32 v29, v29
  v_mfma_f32_16x16x32_bf16 v[48:51], a[204:207], v[204:207], v[48:51]
  ds_read_b128 a[212:215], v169 offset:19456
  v_cvt_pk_bf16_f32 v136, v28, v29
  v_mfma_f32_16x16x32_bf16 v[52:55], a[204:207], v[220:223], v[148:151]
  v_exp_f32 v30, v30
  v_mfma_f32_16x16x32_bf16 v[52:55], a[200:203], v[216:219], v[52:55]
  ds_read_b128 a[216:219], v170 offset:19456
  v_mfma_f32_16x16x32_bf16 v[52:55], a[196:199], v[212:215], v[52:55]
  v_exp_f32 v31, v31
  v_mfma_f32_16x16x32_bf16 v[52:55], a[192:195], v[208:211], v[52:55]
  ds_read_b128 a[220:223], v171 offset:19456
  v_cvt_pk_bf16_f32 v137, v30, v31
  v_mfma_f32_16x16x32_bf16 v[56:59], a[192:195], v[224:227], v[152:155]
  v_exp_f32 v32, v32
  v_mfma_f32_16x16x32_bf16 v[56:59], a[196:199], v[228:231], v[56:59]
  ds_read_b64_tr_b16 a[140:141], v173 offset:2048
  v_xor_b32 v168, s33, v168
  v_mfma_f32_16x16x32_bf16 v[56:59], a[200:203], v[232:235], v[56:59]
  v_exp_f32 v33, v33
  v_mfma_f32_16x16x32_bf16 v[56:59], a[204:207], v[236:239], v[56:59]
  v_cvt_pk_bf16_f32 v114, v32, v33
  v_mfma_f32_16x16x32_bf16 v[60:63], a[204:207], v[252:255], v[156:159]
  v_exp_f32 v34, v34
  v_mfma_f32_16x16x32_bf16 v[60:63], a[200:203], v[248:251], v[60:63]
  buffer_load_dwordx4 v181, s[20:23], s30 offen offset:2048 lds
  v_mfma_f32_16x16x32_bf16 v[60:63], a[196:199], v[244:247], v[60:63]
  v_exp_f32 v35, v35
  v_mfma_f32_16x16x32_bf16 v[60:63], a[192:195], v[240:243], v[60:63]
  s_waitcnt lgkmcnt(1)
  ds_read_b64_tr_b16 a[142:143], v173 offset:3072
  v_cvt_pk_bf16_f32 v115, v34, v35
  v_mfma_f32_16x16x32_bf16 v[64:67], a[208:211], v[192:195], v[144:147]
  v_exp_f32 v36, v36
  v_mfma_f32_16x16x32_bf16 v[64:67], a[212:215], v[196:199], v[64:67]
  ds_read_b64_tr_b16 a[144:145], v174 offset:0
  v_xor_b32 v169, s33, v169
  v_mfma_f32_16x16x32_bf16 v[64:67], a[216:219], v[200:203], v[64:67]
  v_exp_f32 v37, v37
  v_mfma_f32_16x16x32_bf16 v[64:67], a[220:223], v[204:207], v[64:67]
  ds_read_b64_tr_b16 a[146:147], v174 offset:1024
  v_cvt_pk_bf16_f32 v122, v36, v37
  v_mfma_f32_16x16x32_bf16 v[68:71], a[220:223], v[220:223], v[148:151]
  v_exp_f32 v38, v38
  v_mfma_f32_16x16x32_bf16 v[68:71], a[216:219], v[216:219], v[68:71]
  ds_read_b64_tr_b16 a[148:149], v174 offset:2048
  v_mfma_f32_16x16x32_bf16 v[68:71], a[212:215], v[212:215], v[68:71]
  v_exp_f32 v39, v39
  v_mfma_f32_16x16x32_bf16 v[68:71], a[208:211], v[208:211], v[68:71]
  ds_read_b64_tr_b16 a[150:151], v174 offset:3072
  v_cvt_pk_bf16_f32 v123, v38, v39
  v_mfma_f32_16x16x32_bf16 v[72:75], a[208:211], v[224:227], v[152:155]
  v_exp_f32 v40, v40
  v_mfma_f32_16x16x32_bf16 v[72:75], a[212:215], v[228:231], v[72:75]
  buffer_load_dwordx4 v181, s[20:23], s30 offen offset:3072 lds
  v_mfma_f32_16x16x32_bf16 v[72:75], a[216:219], v[232:235], v[72:75]
  s_addk_i32 s30, 0x4000
  v_exp_f32 v41, v41
  v_mfma_f32_16x16x32_bf16 v[72:75], a[220:223], v[236:239], v[72:75]
  ds_read_b64_tr_b16 a[152:153], v175 offset:0
  v_cvt_pk_bf16_f32 v130, v40, v41
  v_mfma_f32_16x16x32_bf16 v[76:79], a[220:223], v[252:255], v[156:159]
  v_exp_f32 v42, v42
  v_mfma_f32_16x16x32_bf16 v[76:79], a[216:219], v[248:251], v[76:79]
  v_xor_b32 v170, s33, v170
  v_mfma_f32_16x16x32_bf16 v[76:79], a[212:215], v[244:247], v[76:79]
  v_exp_f32 v43, v43
  v_mfma_f32_16x16x32_bf16 v[76:79], a[208:211], v[240:243], v[76:79]
  v_exp_f32 v44, v44
  v_smfmac_f32_16x16x64_bf16 a[224:227], a[240:243], v[80:87], v189
  ds_read_b64_tr_b16 a[154:155], v175 offset:1024
  v_smfmac_f32_16x16x64_bf16 a[228:231], a[240:243], v[88:95], v189
  ds_read_b64_tr_b16 a[156:157], v175 offset:2048
  v_smfmac_f32_16x16x64_bf16 a[232:235], a[240:243], v[96:103], v189
  ds_read_b64_tr_b16 a[158:159], v175 offset:3072
  v_smfmac_f32_16x16x64_bf16 a[236:239], a[240:243], v[104:111], v189
  ds_read_b64_tr_b16 a[160:161], v176 offset:0
  v_mfma_f32_16x16x32_bf16 a[0:3], a[128:131], v[80:83], a[0:3]
  v_exp_f32 v45, v45
  v_mfma_f32_16x16x32_bf16 a[0:3], a[132:135], v[84:87], a[0:3]
  ds_read_b64_tr_b16 a[162:163], v176 offset:1024
  v_cvt_pk_bf16_f32 v131, v42, v43
  v_mfma_f32_16x16x32_bf16 a[4:7], a[132:135], v[92:95], a[4:7]
  v_exp_f32 v46, v46
  v_mfma_f32_16x16x32_bf16 a[4:7], a[128:131], v[88:91], a[4:7]
  ds_read_b64_tr_b16 a[164:165], v176 offset:2048
  v_cvt_pk_bf16_f32 v138, v44, v45
  v_mfma_f32_16x16x32_bf16 a[8:11], a[128:131], v[96:99], a[8:11]
  s_pack_ll_b32_b16 m0, s29, 0
  v_exp_f32 v47, v47
  v_mfma_f32_16x16x32_bf16 a[8:11], a[132:135], v[100:103], a[8:11]
  buffer_load_dwordx4 v180, s[16:19], s29 offen offset:0 lds
  v_mfma_f32_16x16x32_bf16 a[12:15], a[132:135], v[108:111], a[12:15]
  v_exp_f32 v48, v48
  v_mfma_f32_16x16x32_bf16 a[12:15], a[128:131], v[104:107], a[12:15]
  s_waitcnt lgkmcnt(11)
  ds_read_b64_tr_b16 a[166:167], v176 offset:3072
  v_cvt_pk_bf16_f32 v139, v46, v47
  v_mfma_f32_16x16x32_bf16 a[16:19], a[136:139], v[80:83], a[16:19]
  v_exp_f32 v49, v49
  v_mfma_f32_16x16x32_bf16 a[16:19], a[140:143], v[84:87], a[16:19]
  v_cvt_pk_bf16_f32 v116, v48, v49
  v_xor_b32 v171, s33, v171
  v_mfma_f32_16x16x32_bf16 a[20:23], a[140:143], v[92:95], a[20:23]
  v_exp_f32 v50, v50
  v_mfma_f32_16x16x32_bf16 a[20:23], a[136:139], v[88:91], a[20:23]
  ds_read_b64_tr_b16 a[168:169], v177 offset:0
  v_mfma_f32_16x16x32_bf16 a[24:27], a[136:139], v[96:99], a[24:27]
  v_exp_f32 v51, v51
  v_mfma_f32_16x16x32_bf16 a[24:27], a[140:143], v[100:103], a[24:27]
  ds_read_b64_tr_b16 a[170:171], v177 offset:1024
  v_cvt_pk_bf16_f32 v117, v50, v51
  v_mfma_f32_16x16x32_bf16 a[28:31], a[140:143], v[108:111], a[28:31]
  v_exp_f32 v52, v52
  v_mfma_f32_16x16x32_bf16 a[28:31], a[136:139], v[104:107], a[28:31]
  s_waitcnt lgkmcnt(10)
  ds_read_b64_tr_b16 a[172:173], v177 offset:2048
  v_mfma_f32_16x16x32_bf16 a[32:35], a[144:147], v[80:83], a[32:35]
  v_exp_f32 v53, v53
  v_mfma_f32_16x16x32_bf16 a[32:35], a[148:151], v[84:87], a[32:35]
  buffer_load_dwordx4 v180, s[16:19], s29 offen offset:1024 lds
  v_mfma_f32_16x16x32_bf16 a[36:39], a[148:151], v[92:95], a[36:39]
  v_exp_f32 v54, v54
  v_mfma_f32_16x16x32_bf16 a[36:39], a[144:147], v[88:91], a[36:39]
  ds_read_b64_tr_b16 a[174:175], v177 offset:3072
  v_cvt_pk_bf16_f32 v124, v52, v53
  v_mfma_f32_16x16x32_bf16 a[40:43], a[144:147], v[96:99], a[40:43]
  v_exp_f32 v55, v55
  v_mfma_f32_16x16x32_bf16 a[40:43], a[148:151], v[100:103], a[40:43]
  ds_read_b64_tr_b16 a[176:177], v178 offset:0
  v_cvt_pk_bf16_f32 v125, v54, v55
  v_mfma_f32_16x16x32_bf16 a[44:47], a[148:151], v[108:111], a[44:47]
  v_exp_f32 v56, v56
  v_mfma_f32_16x16x32_bf16 a[44:47], a[144:147], v[104:107], a[44:47]
  s_waitcnt lgkmcnt(9)
  ds_read_b64_tr_b16 a[178:179], v178 offset:1024
  v_mfma_f32_16x16x32_bf16 a[48:51], a[152:155], v[80:83], a[48:51]
  v_exp_f32 v57, v57
  v_mfma_f32_16x16x32_bf16 a[48:51], a[156:159], v[84:87], a[48:51]
  v_cvt_pk_bf16_f32 v132, v56, v57
  v_mfma_f32_16x16x32_bf16 a[52:55], a[156:159], v[92:95], a[52:55]
  v_exp_f32 v58, v58
  v_mfma_f32_16x16x32_bf16 a[52:55], a[152:155], v[88:91], a[52:55]
  ds_read_b64_tr_b16 a[180:181], v178 offset:2048
  v_mfma_f32_16x16x32_bf16 a[56:59], a[152:155], v[96:99], a[56:59]
  v_exp_f32 v59, v59
  v_mfma_f32_16x16x32_bf16 a[56:59], a[156:159], v[100:103], a[56:59]
  buffer_load_dwordx4 v180, s[16:19], s29 offen offset:2048 lds
  v_mfma_f32_16x16x32_bf16 a[60:63], a[156:159], v[108:111], a[60:63]
  v_exp_f32 v60, v60
  v_mfma_f32_16x16x32_bf16 a[60:63], a[152:155], v[104:107], a[60:63]
  s_waitcnt lgkmcnt(7)
  ds_read_b64_tr_b16 a[182:183], v178 offset:3072
  v_cvt_pk_bf16_f32 v133, v58, v59
  v_mfma_f32_16x16x32_bf16 a[64:67], a[160:163], v[80:83], a[64:67]
  v_exp_f32 v61, v61
  v_mfma_f32_16x16x32_bf16 a[64:67], a[164:167], v[84:87], a[64:67]
  ds_read_b64_tr_b16 a[184:185], v179 offset:0
  v_cvt_pk_bf16_f32 v140, v60, v61
  v_mfma_f32_16x16x32_bf16 a[68:71], a[164:167], v[92:95], a[68:71]
  v_exp_f32 v62, v62
  v_mfma_f32_16x16x32_bf16 a[68:71], a[160:163], v[88:91], a[68:71]
  ds_read_b64_tr_b16 a[186:187], v179 offset:1024
  v_mfma_f32_16x16x32_bf16 a[72:75], a[160:163], v[96:99], a[72:75]
  v_exp_f32 v63, v63
  v_mfma_f32_16x16x32_bf16 a[72:75], a[164:167], v[100:103], a[72:75]
  ds_read_b64_tr_b16 a[188:189], v179 offset:2048
  v_cvt_pk_bf16_f32 v141, v62, v63
  v_mfma_f32_16x16x32_bf16 a[76:79], a[164:167], v[108:111], a[76:79]
  v_exp_f32 v64, v64
  v_mfma_f32_16x16x32_bf16 a[76:79], a[160:163], v[104:107], a[76:79]
  s_waitcnt lgkmcnt(7)
  ds_read_b64_tr_b16 a[190:191], v179 offset:3072
  v_mfma_f32_16x16x32_bf16 a[80:83], a[168:171], v[80:83], a[80:83]
  v_exp_f32 v65, v65
  v_mfma_f32_16x16x32_bf16 a[80:83], a[172:175], v[84:87], a[80:83]
  buffer_load_dwordx4 v180, s[16:19], s29 offen offset:3072 lds
  v_mfma_f32_16x16x32_bf16 a[84:87], a[172:175], v[92:95], a[84:87]
  s_addk_i32 s29, 0x4000
  v_exp_f32 v66, v66
  v_mfma_f32_16x16x32_bf16 a[84:87], a[168:171], v[88:91], a[84:87]
  v_cvt_pk_bf16_f32 v118, v64, v65
  v_mfma_f32_16x16x32_bf16 a[88:91], a[168:171], v[96:99], a[88:91]
  v_exp_f32 v67, v67
  v_mfma_f32_16x16x32_bf16 a[88:91], a[172:175], v[100:103], a[88:91]
  s_waitcnt vmcnt(8)
  v_cvt_pk_bf16_f32 v119, v66, v67
  v_mfma_f32_16x16x32_bf16 a[92:95], a[172:175], v[108:111], a[92:95]
  s_barrier
  v_mfma_f32_16x16x32_bf16 a[92:95], a[168:171], v[104:107], a[92:95]
  s_waitcnt lgkmcnt(4)
  v_exp_f32 v68, v68
  v_mfma_f32_16x16x32_bf16 a[96:99], a[176:179], v[80:83], a[96:99]
  v_mfma_f32_16x16x32_bf16 a[96:99], a[180:183], v[84:87], a[96:99]
  v_exp_f32 v69, v69
  v_mfma_f32_16x16x32_bf16 a[100:103], a[180:183], v[92:95], a[100:103]
  ds_read_b128 a[192:195], v168 offset:0
  v_cvt_pk_bf16_f32 v126, v68, v69
  v_mfma_f32_16x16x32_bf16 a[100:103], a[176:179], v[88:91], a[100:103]
  v_exp_f32 v70, v70
  v_mfma_f32_16x16x32_bf16 a[104:107], a[176:179], v[96:99], a[104:107]
  ds_read_b128 a[196:199], v169 offset:0
  v_mfma_f32_16x16x32_bf16 a[104:107], a[180:183], v[100:103], a[104:107]
  v_exp_f32 v71, v71
  v_mfma_f32_16x16x32_bf16 a[108:111], a[180:183], v[108:111], a[108:111]
  ds_read_b128 a[200:203], v170 offset:0
  v_cvt_pk_bf16_f32 v127, v70, v71
  v_mfma_f32_16x16x32_bf16 a[108:111], a[176:179], v[104:107], a[108:111]
  s_waitcnt lgkmcnt(3)
  v_exp_f32 v72, v72
  v_mfma_f32_16x16x32_bf16 a[112:115], a[184:187], v[80:83], a[112:115]
  ds_read_b128 a[204:207], v171 offset:0
  v_mfma_f32_16x16x32_bf16 a[112:115], a[188:191], v[84:87], a[112:115]
  v_exp_f32 v73, v73
  v_mfma_f32_16x16x32_bf16 a[116:119], a[188:191], v[92:95], a[116:119]
  v_cvt_pk_bf16_f32 v134, v72, v73
  v_mfma_f32_16x16x32_bf16 a[116:119], a[184:187], v[88:91], a[116:119]
  v_exp_f32 v74, v74
  v_mfma_f32_16x16x32_bf16 a[120:123], a[184:187], v[96:99], a[120:123]
  v_mfma_f32_16x16x32_bf16 a[120:123], a[188:191], v[100:103], a[120:123]
  v_exp_f32 v75, v75
  v_mfma_f32_16x16x32_bf16 a[124:127], a[188:191], v[108:111], a[124:127]
  s_waitcnt lgkmcnt(0)
  v_cvt_pk_bf16_f32 v135, v74, v75
  v_mfma_f32_16x16x32_bf16 a[124:127], a[184:187], v[104:107], a[124:127]
  v_mfma_f32_16x16x32_bf16 v[16:19], a[192:195], v[192:195], v[144:147]
  v_exp_f32 v76, v76
  v_mfma_f32_16x16x32_bf16 v[16:19], a[196:199], v[196:199], v[16:19]
  ds_read_b128 a[208:211], v168 offset:1024
  v_mfma_f32_16x16x32_bf16 v[16:19], a[200:203], v[200:203], v[16:19]
  v_exp_f32 v77, v77
  v_mfma_f32_16x16x32_bf16 v[16:19], a[204:207], v[204:207], v[16:19]
  ds_read_b128 a[212:215], v169 offset:1024
  v_cvt_pk_bf16_f32 v142, v76, v77
  v_mfma_f32_16x16x32_bf16 v[20:23], a[204:207], v[220:223], v[148:151]
  v_exp_f32 v78, v78
  v_mfma_f32_16x16x32_bf16 v[20:23], a[200:203], v[216:219], v[20:23]
  ds_read_b128 a[216:219], v170 offset:1024
  v_mfma_f32_16x16x32_bf16 v[20:23], a[196:199], v[212:215], v[20:23]
  v_exp_f32 v79, v79
  v_mfma_f32_16x16x32_bf16 v[20:23], a[192:195], v[208:211], v[20:23]
  ds_read_b128 a[220:223], v171 offset:1024
  v_cvt_pk_bf16_f32 v143, v78, v79
  v_mfma_f32_16x16x32_bf16 v[24:27], a[192:195], v[224:227], v[152:155]
  v_exp_f32 v16, v16
  v_mfma_f32_16x16x32_bf16 v[24:27], a[196:199], v[228:231], v[24:27]
  ds_read_b64_tr_b16 a[128:129], v172 offset:16384
  v_mfma_f32_16x16x32_bf16 v[24:27], a[200:203], v[232:235], v[24:27]
  v_exp_f32 v17, v17
  v_mfma_f32_16x16x32_bf16 v[24:27], a[204:207], v[236:239], v[24:27]
  ds_read_b64_tr_b16 a[130:131], v172 offset:17408
  v_cvt_pk_bf16_f32 v80, v16, v17
  v_mfma_f32_16x16x32_bf16 v[28:31], a[204:207], v[252:255], v[156:159]
  s_pack_ll_b32_b16 m0, s30, 1
  v_exp_f32 v18, v18
  v_mfma_f32_16x16x32_bf16 v[28:31], a[200:203], v[248:251], v[28:31]
  buffer_load_dwordx4 v181, s[20:23], s30 offen offset:0 lds
  v_mfma_f32_16x16x32_bf16 v[28:31], a[196:199], v[244:247], v[28:31]
  v_exp_f32 v19, v19
  v_mfma_f32_16x16x32_bf16 v[28:31], a[192:195], v[240:243], v[28:31]
  s_waitcnt lgkmcnt(2)
  ds_read_b64_tr_b16 a[132:133], v172 offset:18432
  v_cvt_pk_bf16_f32 v81, v18, v19
  v_mfma_f32_16x16x32_bf16 v[32:35], a[208:211], v[192:195], v[144:147]
  v_exp_f32 v20, v20
  v_mfma_f32_16x16x32_bf16 v[32:35], a[212:215], v[196:199], v[32:35]
  ds_read_b128 a[192:195], v168 offset:2048
  v_mfma_f32_16x16x32_bf16 v[32:35], a[216:219], v[200:203], v[32:35]
  v_exp_f32 v21, v21
  v_mfma_f32_16x16x32_bf16 v[32:35], a[220:223], v[204:207], v[32:35]
  ds_read_b128 a[196:199], v169 offset:2048
  v_cvt_pk_bf16_f32 v88, v20, v21
  v_mfma_f32_16x16x32_bf16 v[36:39], a[220:223], v[220:223], v[148:151]
  v_exp_f32 v22, v22
  v_mfma_f32_16x16x32_bf16 v[36:39], a[216:219], v[216:219], v[36:39]
  ds_read_b128 a[200:203], v170 offset:2048
  v_mfma_f32_16x16x32_bf16 v[36:39], a[212:215], v[212:215], v[36:39]
  v_exp_f32 v23, v23
  v_mfma_f32_16x16x32_bf16 v[36:39], a[208:211], v[208:211], v[36:39]
  ds_read_b128 a[204:207], v171 offset:2048
  v_cvt_pk_bf16_f32 v89, v22, v23
  v_mfma_f32_16x16x32_bf16 v[40:43], a[208:211], v[224:227], v[152:155]
  v_exp_f32 v24, v24
  v_mfma_f32_16x16x32_bf16 v[40:43], a[212:215], v[228:231], v[40:43]
  ds_read_b64_tr_b16 a[134:135], v172 offset:19456
  v_mfma_f32_16x16x32_bf16 v[40:43], a[216:219], v[232:235], v[40:43]
  v_exp_f32 v25, v25
  v_mfma_f32_16x16x32_bf16 v[40:43], a[220:223], v[236:239], v[40:43]
  ds_read_b64_tr_b16 a[136:137], v173 offset:16384
  v_cvt_pk_bf16_f32 v96, v24, v25
  v_mfma_f32_16x16x32_bf16 v[44:47], a[220:223], v[252:255], v[156:159]
  v_exp_f32 v26, v26
  v_mfma_f32_16x16x32_bf16 v[44:47], a[216:219], v[248:251], v[44:47]
  buffer_load_dwordx4 v181, s[20:23], s30 offen offset:1024 lds
  v_mfma_f32_16x16x32_bf16 v[44:47], a[212:215], v[244:247], v[44:47]
  v_exp_f32 v27, v27
  v_mfma_f32_16x16x32_bf16 v[44:47], a[208:211], v[240:243], v[44:47]
  s_waitcnt lgkmcnt(2)
  ds_read_b64_tr_b16 a[138:139], v173 offset:17408
  v_cvt_pk_bf16_f32 v97, v26, v27
  v_mfma_f32_16x16x32_bf16 v[48:51], a[192:195], v[192:195], v[144:147]
  v_exp_f32 v28, v28
  v_mfma_f32_16x16x32_bf16 v[48:51], a[196:199], v[196:199], v[48:51]
  ds_read_b128 a[208:211], v168 offset:3072
  v_mfma_f32_16x16x32_bf16 v[48:51], a[200:203], v[200:203], v[48:51]
  v_exp_f32 v29, v29
  v_mfma_f32_16x16x32_bf16 v[48:51], a[204:207], v[204:207], v[48:51]
  ds_read_b128 a[212:215], v169 offset:3072
  v_cvt_pk_bf16_f32 v104, v28, v29
  v_mfma_f32_16x16x32_bf16 v[52:55], a[204:207], v[220:223], v[148:151]
  v_exp_f32 v30, v30
  v_mfma_f32_16x16x32_bf16 v[52:55], a[200:203], v[216:219], v[52:55]
  ds_read_b128 a[216:219], v170 offset:3072
  v_mfma_f32_16x16x32_bf16 v[52:55], a[196:199], v[212:215], v[52:55]
  v_exp_f32 v31, v31
  v_mfma_f32_16x16x32_bf16 v[52:55], a[192:195], v[208:211], v[52:55]
  ds_read_b128 a[220:223], v171 offset:3072
  v_cvt_pk_bf16_f32 v105, v30, v31
  v_mfma_f32_16x16x32_bf16 v[56:59], a[192:195], v[224:227], v[152:155]
  v_exp_f32 v32, v32
  v_mfma_f32_16x16x32_bf16 v[56:59], a[196:199], v[228:231], v[56:59]
  ds_read_b64_tr_b16 a[140:141], v173 offset:18432
  v_xor_b32 v172, s33, v172
  v_mfma_f32_16x16x32_bf16 v[56:59], a[200:203], v[232:235], v[56:59]
  v_exp_f32 v33, v33
  v_mfma_f32_16x16x32_bf16 v[56:59], a[204:207], v[236:239], v[56:59]
  v_cvt_pk_bf16_f32 v82, v32, v33
  v_mfma_f32_16x16x32_bf16 v[60:63], a[204:207], v[252:255], v[156:159]
  v_exp_f32 v34, v34
  v_mfma_f32_16x16x32_bf16 v[60:63], a[200:203], v[248:251], v[60:63]
  buffer_load_dwordx4 v181, s[20:23], s30 offen offset:2048 lds
  v_mfma_f32_16x16x32_bf16 v[60:63], a[196:199], v[244:247], v[60:63]
  v_exp_f32 v35, v35
  v_mfma_f32_16x16x32_bf16 v[60:63], a[192:195], v[240:243], v[60:63]
  s_waitcnt lgkmcnt(1)
  ds_read_b64_tr_b16 a[142:143], v173 offset:19456
  v_cvt_pk_bf16_f32 v83, v34, v35
  v_mfma_f32_16x16x32_bf16 v[64:67], a[208:211], v[192:195], v[144:147]
  v_exp_f32 v36, v36
  v_mfma_f32_16x16x32_bf16 v[64:67], a[212:215], v[196:199], v[64:67]
  ds_read_b64_tr_b16 a[144:145], v174 offset:16384
  v_xor_b32 v173, s33, v173
  v_mfma_f32_16x16x32_bf16 v[64:67], a[216:219], v[200:203], v[64:67]
  v_exp_f32 v37, v37
  v_mfma_f32_16x16x32_bf16 v[64:67], a[220:223], v[204:207], v[64:67]
  ds_read_b64_tr_b16 a[146:147], v174 offset:17408
  v_cvt_pk_bf16_f32 v90, v36, v37
  v_mfma_f32_16x16x32_bf16 v[68:71], a[220:223], v[220:223], v[148:151]
  v_exp_f32 v38, v38
  v_mfma_f32_16x16x32_bf16 v[68:71], a[216:219], v[216:219], v[68:71]
  ds_read_b64_tr_b16 a[148:149], v174 offset:18432
  v_mfma_f32_16x16x32_bf16 v[68:71], a[212:215], v[212:215], v[68:71]
  v_exp_f32 v39, v39
  v_mfma_f32_16x16x32_bf16 v[68:71], a[208:211], v[208:211], v[68:71]
  ds_read_b64_tr_b16 a[150:151], v174 offset:19456
  v_cvt_pk_bf16_f32 v91, v38, v39
  v_mfma_f32_16x16x32_bf16 v[72:75], a[208:211], v[224:227], v[152:155]
  v_exp_f32 v40, v40
  v_mfma_f32_16x16x32_bf16 v[72:75], a[212:215], v[228:231], v[72:75]
  buffer_load_dwordx4 v181, s[20:23], s30 offen offset:3072 lds
  v_mfma_f32_16x16x32_bf16 v[72:75], a[216:219], v[232:235], v[72:75]
  s_addk_i32 s30, 0x4000
  v_exp_f32 v41, v41
  v_mfma_f32_16x16x32_bf16 v[72:75], a[220:223], v[236:239], v[72:75]
  ds_read_b64_tr_b16 a[152:153], v175 offset:16384
  v_cvt_pk_bf16_f32 v98, v40, v41
  v_mfma_f32_16x16x32_bf16 v[76:79], a[220:223], v[252:255], v[156:159]
  v_exp_f32 v42, v42
  v_mfma_f32_16x16x32_bf16 v[76:79], a[216:219], v[248:251], v[76:79]
  v_xor_b32 v174, s33, v174
  v_mfma_f32_16x16x32_bf16 v[76:79], a[212:215], v[244:247], v[76:79]
  v_exp_f32 v43, v43
  v_mfma_f32_16x16x32_bf16 v[76:79], a[208:211], v[240:243], v[76:79]
  v_exp_f32 v44, v44
  v_smfmac_f32_16x16x64_bf16 a[224:227], a[240:243], v[112:119], v189
  ds_read_b64_tr_b16 a[154:155], v175 offset:17408
  v_smfmac_f32_16x16x64_bf16 a[228:231], a[240:243], v[120:127], v189
  ds_read_b64_tr_b16 a[156:157], v175 offset:18432
  v_smfmac_f32_16x16x64_bf16 a[232:235], a[240:243], v[128:135], v189
  ds_read_b64_tr_b16 a[158:159], v175 offset:19456
  v_smfmac_f32_16x16x64_bf16 a[236:239], a[240:243], v[136:143], v189
  ds_read_b64_tr_b16 a[160:161], v176 offset:16384
  v_mfma_f32_16x16x32_bf16 a[0:3], a[128:131], v[112:115], a[0:3]
  v_exp_f32 v45, v45
  v_mfma_f32_16x16x32_bf16 a[0:3], a[132:135], v[116:119], a[0:3]
  ds_read_b64_tr_b16 a[162:163], v176 offset:17408
  v_cvt_pk_bf16_f32 v99, v42, v43
  v_mfma_f32_16x16x32_bf16 a[4:7], a[132:135], v[124:127], a[4:7]
  v_exp_f32 v46, v46
  v_mfma_f32_16x16x32_bf16 a[4:7], a[128:131], v[120:123], a[4:7]
  ds_read_b64_tr_b16 a[164:165], v176 offset:18432
  v_cvt_pk_bf16_f32 v106, v44, v45
  v_mfma_f32_16x16x32_bf16 a[8:11], a[128:131], v[128:131], a[8:11]
  s_pack_ll_b32_b16 m0, s29, 0
  v_exp_f32 v47, v47
  v_mfma_f32_16x16x32_bf16 a[8:11], a[132:135], v[132:135], a[8:11]
  buffer_load_dwordx4 v180, s[16:19], s29 offen offset:0 lds
  v_mfma_f32_16x16x32_bf16 a[12:15], a[132:135], v[140:143], a[12:15]
  v_exp_f32 v48, v48
  v_mfma_f32_16x16x32_bf16 a[12:15], a[128:131], v[136:139], a[12:15]
  s_waitcnt lgkmcnt(11)
  ds_read_b64_tr_b16 a[166:167], v176 offset:19456
  v_cvt_pk_bf16_f32 v107, v46, v47
  v_mfma_f32_16x16x32_bf16 a[16:19], a[136:139], v[112:115], a[16:19]
  v_exp_f32 v49, v49
  v_mfma_f32_16x16x32_bf16 a[16:19], a[140:143], v[116:119], a[16:19]
  v_cvt_pk_bf16_f32 v84, v48, v49
  v_xor_b32 v175, s33, v175
  v_mfma_f32_16x16x32_bf16 a[20:23], a[140:143], v[124:127], a[20:23]
  v_exp_f32 v50, v50
  v_mfma_f32_16x16x32_bf16 a[20:23], a[136:139], v[120:123], a[20:23]
  ds_read_b64_tr_b16 a[168:169], v177 offset:16384
  v_xor_b32 v176, s33, v176
  v_mfma_f32_16x16x32_bf16 a[24:27], a[136:139], v[128:131], a[24:27]
  v_exp_f32 v51, v51
  v_mfma_f32_16x16x32_bf16 a[24:27], a[140:143], v[132:135], a[24:27]
  ds_read_b64_tr_b16 a[170:171], v177 offset:17408
  v_cvt_pk_bf16_f32 v85, v50, v51
  v_mfma_f32_16x16x32_bf16 a[28:31], a[140:143], v[140:143], a[28:31]
  v_exp_f32 v52, v52
  v_mfma_f32_16x16x32_bf16 a[28:31], a[136:139], v[136:139], a[28:31]
  s_waitcnt lgkmcnt(10)
  ds_read_b64_tr_b16 a[172:173], v177 offset:18432
  v_mfma_f32_16x16x32_bf16 a[32:35], a[144:147], v[112:115], a[32:35]
  v_exp_f32 v53, v53
  v_mfma_f32_16x16x32_bf16 a[32:35], a[148:151], v[116:119], a[32:35]
  buffer_load_dwordx4 v180, s[16:19], s29 offen offset:1024 lds
  v_mfma_f32_16x16x32_bf16 a[36:39], a[148:151], v[124:127], a[36:39]
  v_exp_f32 v54, v54
  v_mfma_f32_16x16x32_bf16 a[36:39], a[144:147], v[120:123], a[36:39]
  ds_read_b64_tr_b16 a[174:175], v177 offset:19456
  v_cvt_pk_bf16_f32 v92, v52, v53
  v_mfma_f32_16x16x32_bf16 a[40:43], a[144:147], v[128:131], a[40:43]
  v_exp_f32 v55, v55
  v_mfma_f32_16x16x32_bf16 a[40:43], a[148:151], v[132:135], a[40:43]
  ds_read_b64_tr_b16 a[176:177], v178 offset:16384
  v_cvt_pk_bf16_f32 v93, v54, v55
  v_mfma_f32_16x16x32_bf16 a[44:47], a[148:151], v[140:143], a[44:47]
  v_exp_f32 v56, v56
  v_mfma_f32_16x16x32_bf16 a[44:47], a[144:147], v[136:139], a[44:47]
  s_waitcnt lgkmcnt(9)
  ds_read_b64_tr_b16 a[178:179], v178 offset:17408
  v_xor_b32 v177, s33, v177
  v_mfma_f32_16x16x32_bf16 a[48:51], a[152:155], v[112:115], a[48:51]
  v_exp_f32 v57, v57
  v_mfma_f32_16x16x32_bf16 a[48:51], a[156:159], v[116:119], a[48:51]
  v_cvt_pk_bf16_f32 v100, v56, v57
  v_mfma_f32_16x16x32_bf16 a[52:55], a[156:159], v[124:127], a[52:55]
  v_exp_f32 v58, v58
  v_mfma_f32_16x16x32_bf16 a[52:55], a[152:155], v[120:123], a[52:55]
  ds_read_b64_tr_b16 a[180:181], v178 offset:18432
  v_mfma_f32_16x16x32_bf16 a[56:59], a[152:155], v[128:131], a[56:59]
  v_exp_f32 v59, v59
  v_mfma_f32_16x16x32_bf16 a[56:59], a[156:159], v[132:135], a[56:59]
  buffer_load_dwordx4 v180, s[16:19], s29 offen offset:2048 lds
  v_mfma_f32_16x16x32_bf16 a[60:63], a[156:159], v[140:143], a[60:63]
  v_exp_f32 v60, v60
  v_mfma_f32_16x16x32_bf16 a[60:63], a[152:155], v[136:139], a[60:63]
  s_waitcnt lgkmcnt(7)
  ds_read_b64_tr_b16 a[182:183], v178 offset:19456
  v_cvt_pk_bf16_f32 v101, v58, v59
  v_mfma_f32_16x16x32_bf16 a[64:67], a[160:163], v[112:115], a[64:67]
  v_exp_f32 v61, v61
  v_mfma_f32_16x16x32_bf16 a[64:67], a[164:167], v[116:119], a[64:67]
  ds_read_b64_tr_b16 a[184:185], v179 offset:16384
  v_cvt_pk_bf16_f32 v108, v60, v61
  v_mfma_f32_16x16x32_bf16 a[68:71], a[164:167], v[124:127], a[68:71]
  v_exp_f32 v62, v62
  v_mfma_f32_16x16x32_bf16 a[68:71], a[160:163], v[120:123], a[68:71]
  ds_read_b64_tr_b16 a[186:187], v179 offset:17408
  v_xor_b32 v178, s33, v178
  v_mfma_f32_16x16x32_bf16 a[72:75], a[160:163], v[128:131], a[72:75]
  v_exp_f32 v63, v63
  v_mfma_f32_16x16x32_bf16 a[72:75], a[164:167], v[132:135], a[72:75]
  ds_read_b64_tr_b16 a[188:189], v179 offset:18432
  v_cvt_pk_bf16_f32 v109, v62, v63
  v_mfma_f32_16x16x32_bf16 a[76:79], a[164:167], v[140:143], a[76:79]
  v_exp_f32 v64, v64
  v_mfma_f32_16x16x32_bf16 a[76:79], a[160:163], v[136:139], a[76:79]
  s_waitcnt lgkmcnt(7)
  ds_read_b64_tr_b16 a[190:191], v179 offset:19456
  v_mfma_f32_16x16x32_bf16 a[80:83], a[168:171], v[112:115], a[80:83]
  v_exp_f32 v65, v65
  v_mfma_f32_16x16x32_bf16 a[80:83], a[172:175], v[116:119], a[80:83]
  buffer_load_dwordx4 v180, s[16:19], s29 offen offset:3072 lds
  v_mfma_f32_16x16x32_bf16 a[84:87], a[172:175], v[124:127], a[84:87]
  s_addk_i32 s29, 0x4000
  v_exp_f32 v66, v66
  v_mfma_f32_16x16x32_bf16 a[84:87], a[168:171], v[120:123], a[84:87]
  v_cvt_pk_bf16_f32 v86, v64, v65
  v_xor_b32 v179, s33, v179
  v_mfma_f32_16x16x32_bf16 a[88:91], a[168:171], v[128:131], a[88:91]
  v_exp_f32 v67, v67
  v_mfma_f32_16x16x32_bf16 a[88:91], a[172:175], v[132:135], a[88:91]
  s_waitcnt vmcnt(8)
  v_cvt_pk_bf16_f32 v87, v66, v67
  v_mfma_f32_16x16x32_bf16 a[92:95], a[172:175], v[140:143], a[92:95]
  s_barrier
  v_mfma_f32_16x16x32_bf16 a[92:95], a[168:171], v[136:139], a[92:95]
  s_waitcnt lgkmcnt(4)
  v_exp_f32 v68, v68
  v_mfma_f32_16x16x32_bf16 a[96:99], a[176:179], v[112:115], a[96:99]
  v_mfma_f32_16x16x32_bf16 a[96:99], a[180:183], v[116:119], a[96:99]
  v_exp_f32 v69, v69
  v_mfma_f32_16x16x32_bf16 a[100:103], a[180:183], v[124:127], a[100:103]
  ds_read_b128 a[192:195], v168 offset:16384
  v_cvt_pk_bf16_f32 v94, v68, v69
  v_mfma_f32_16x16x32_bf16 a[100:103], a[176:179], v[120:123], a[100:103]
  v_exp_f32 v70, v70
  v_mfma_f32_16x16x32_bf16 a[104:107], a[176:179], v[128:131], a[104:107]
  ds_read_b128 a[196:199], v169 offset:16384
  v_mfma_f32_16x16x32_bf16 a[104:107], a[180:183], v[132:135], a[104:107]
  v_exp_f32 v71, v71
  v_mfma_f32_16x16x32_bf16 a[108:111], a[180:183], v[140:143], a[108:111]
  ds_read_b128 a[200:203], v170 offset:16384
  v_cvt_pk_bf16_f32 v95, v70, v71
  v_mfma_f32_16x16x32_bf16 a[108:111], a[176:179], v[136:139], a[108:111]
  s_waitcnt lgkmcnt(3)
  v_exp_f32 v72, v72
  v_mfma_f32_16x16x32_bf16 a[112:115], a[184:187], v[112:115], a[112:115]
  ds_read_b128 a[204:207], v171 offset:16384
  v_mfma_f32_16x16x32_bf16 a[112:115], a[188:191], v[116:119], a[112:115]
  v_exp_f32 v73, v73
  v_mfma_f32_16x16x32_bf16 a[116:119], a[188:191], v[124:127], a[116:119]
  v_cvt_pk_bf16_f32 v102, v72, v73
  v_mfma_f32_16x16x32_bf16 a[116:119], a[184:187], v[120:123], a[116:119]
  v_exp_f32 v74, v74
  v_mfma_f32_16x16x32_bf16 a[120:123], a[184:187], v[128:131], a[120:123]
  s_sub_u32 s31, s31, 1
  v_mfma_f32_16x16x32_bf16 a[120:123], a[188:191], v[132:135], a[120:123]
  s_cmp_lg_u32 s31, 0
  v_exp_f32 v75, v75
  v_mfma_f32_16x16x32_bf16 a[124:127], a[188:191], v[140:143], a[124:127]
  s_waitcnt lgkmcnt(0)
  v_cvt_pk_bf16_f32 v103, v74, v75
  v_mfma_f32_16x16x32_bf16 a[124:127], a[184:187], v[136:139], a[124:127]
  s_cbranch_scc1 L_loop1
L_tail:
  v_mfma_f32_16x16x32_bf16 v[16:19], a[192:195], v[192:195], v[144:147]
  v_exp_f32 v76, v76
  v_mfma_f32_16x16x32_bf16 v[16:19], a[196:199], v[196:199], v[16:19]
  ds_read_b128 a[208:211], v168 offset:17408
  v_mfma_f32_16x16x32_bf16 v[16:19], a[200:203], v[200:203], v[16:19]
  v_exp_f32 v77, v77
  v_mfma_f32_16x16x32_bf16 v[16:19], a[204:207], v[204:207], v[16:19]
  ds_read_b128 a[212:215], v169 offset:17408
  v_cvt_pk_bf16_f32 v110, v76, v77
  v_mfma_f32_16x16x32_bf16 v[20:23], a[204:207], v[220:223], v[148:151]
  v_exp_f32 v78, v78
  v_mfma_f32_16x16x32_bf16 v[20:23], a[200:203], v[216:219], v[20:23]
  ds_read_b128 a[216:219], v170 offset:17408
  v_mfma_f32_16x16x32_bf16 v[20:23], a[196:199], v[212:215], v[20:23]
  v_exp_f32 v79, v79
  v_mfma_f32_16x16x32_bf16 v[20:23], a[192:195], v[208:211], v[20:23]
  ds_read_b128 a[220:223], v171 offset:17408
  v_cvt_pk_bf16_f32 v111, v78, v79
  v_mfma_f32_16x16x32_bf16 v[24:27], a[192:195], v[224:227], v[152:155]
  v_exp_f32 v16, v16
  v_mfma_f32_16x16x32_bf16 v[24:27], a[196:199], v[228:231], v[24:27]
  v_exp_f32 v17, v17
  v_mfma_f32_16x16x32_bf16 v[24:27], a[200:203], v[232:235], v[24:27]
  v_exp_f32 v18, v18
  v_mfma_f32_16x16x32_bf16 v[24:27], a[204:207], v[236:239], v[24:27]
  v_exp_f32 v19, v19
  v_mfma_f32_16x16x32_bf16 v[28:31], a[204:207], v[252:255], v[156:159]
  ds_read_b64_tr_b16 a[128:129], v172 offset:0
  v_cvt_pk_bf16_f32 v112, v16, v17
  v_mfma_f32_16x16x32_bf16 v[28:31], a[200:203], v[248:251], v[28:31]
  ds_read_b64_tr_b16 a[130:131], v172 offset:1024
  v_cvt_pk_bf16_f32 v113, v18, v19
  v_mfma_f32_16x16x32_bf16 v[28:31], a[196:199], v[244:247], v[28:31]
  ds_read_b64_tr_b16 a[132:133], v172 offset:2048
  v_mfma_f32_16x16x32_bf16 v[28:31], a[192:195], v[240:243], v[28:31]
  s_waitcnt lgkmcnt(3)
  ds_read_b64_tr_b16 a[134:135], v172 offset:3072
  v_mfma_f32_16x16x32_bf16 v[32:35], a[208:211], v[192:195], v[144:147]
  ds_read_b64_tr_b16 a[136:137], v173 offset:0
  v_mfma_f32_16x16x32_bf16 v[32:35], a[212:215], v[196:199], v[32:35]
  ds_read_b128 a[192:195], v168 offset:18432
  v_mfma_f32_16x16x32_bf16 v[32:35], a[216:219], v[200:203], v[32:35]
  ds_read_b64_tr_b16 a[138:139], v173 offset:1024
  v_mfma_f32_16x16x32_bf16 v[32:35], a[220:223], v[204:207], v[32:35]
  ds_read_b128 a[196:199], v169 offset:18432
  v_mfma_f32_16x16x32_bf16 v[36:39], a[220:223], v[220:223], v[148:151]
  ds_read_b64_tr_b16 a[140:141], v173 offset:2048
  v_mfma_f32_16x16x32_bf16 v[36:39], a[216:219], v[216:219], v[36:39]
  ds_read_b128 a[200:203], v170 offset:18432
  v_mfma_f32_16x16x32_bf16 v[36:39], a[212:215], v[212:215], v[36:39]
  ds_read_b64_tr_b16 a[142:143], v173 offset:3072
  v_mfma_f32_16x16x32_bf16 v[36:39], a[208:211], v[208:211], v[36:39]
  ds_read_b128 a[204:207], v171 offset:18432
  v_mfma_f32_16x16x32_bf16 v[40:43], a[208:211], v[224:227], v[152:155]
  v_exp_f32 v32, v32
  v_mfma_f32_16x16x32_bf16 v[40:43], a[212:215], v[228:231], v[40:43]
  v_exp_f32 v33, v33
  v_mfma_f32_16x16x32_bf16 v[40:43], a[216:219], v[232:235], v[40:43]
  v_exp_f32 v34, v34
  v_mfma_f32_16x16x32_bf16 v[40:43], a[220:223], v[236:239], v[40:43]
  v_exp_f32 v35, v35
  v_mfma_f32_16x16x32_bf16 v[44:47], a[220:223], v[252:255], v[156:159]
  ds_read_b64_tr_b16 a[144:145], v174 offset:0
  v_cvt_pk_bf16_f32 v114, v32, v33
  v_mfma_f32_16x16x32_bf16 v[44:47], a[216:219], v[248:251], v[44:47]
  ds_read_b64_tr_b16 a[146:147], v174 offset:1024
  v_cvt_pk_bf16_f32 v115, v34, v35
  v_mfma_f32_16x16x32_bf16 v[44:47], a[212:215], v[244:247], v[44:47]
  ds_read_b64_tr_b16 a[148:149], v174 offset:2048
  v_mfma_f32_16x16x32_bf16 v[44:47], a[208:211], v[240:243], v[44:47]
  s_waitcnt lgkmcnt(3)
  ds_read_b64_tr_b16 a[150:151], v174 offset:3072
  v_mfma_f32_16x16x32_bf16 v[48:51], a[192:195], v[192:195], v[144:147]
  ds_read_b64_tr_b16 a[152:153], v175 offset:0
  v_mfma_f32_16x16x32_bf16 v[48:51], a[196:199], v[196:199], v[48:51]
  ds_read_b128 a[208:211], v168 offset:19456
  v_mfma_f32_16x16x32_bf16 v[48:51], a[200:203], v[200:203], v[48:51]
  ds_read_b64_tr_b16 a[154:155], v175 offset:1024
  v_mfma_f32_16x16x32_bf16 v[48:51], a[204:207], v[204:207], v[48:51]
  ds_read_b128 a[212:215], v169 offset:19456
  v_mfma_f32_16x16x32_bf16 v[52:55], a[204:207], v[220:223], v[148:151]
  ds_read_b64_tr_b16 a[156:157], v175 offset:2048
  v_mfma_f32_16x16x32_bf16 v[52:55], a[200:203], v[216:219], v[52:55]
  ds_read_b128 a[216:219], v170 offset:19456
  v_mfma_f32_16x16x32_bf16 v[52:55], a[196:199], v[212:215], v[52:55]
  ds_read_b64_tr_b16 a[158:159], v175 offset:3072
  v_mfma_f32_16x16x32_bf16 v[52:55], a[192:195], v[208:211], v[52:55]
  ds_read_b128 a[220:223], v171 offset:19456
  v_mfma_f32_16x16x32_bf16 v[56:59], a[192:195], v[224:227], v[152:155]
  v_exp_f32 v48, v48
  v_mfma_f32_16x16x32_bf16 v[56:59], a[196:199], v[228:231], v[56:59]
  v_exp_f32 v49, v49
  v_mfma_f32_16x16x32_bf16 v[56:59], a[200:203], v[232:235], v[56:59]
  v_exp_f32 v50, v50
  v_mfma_f32_16x16x32_bf16 v[56:59], a[204:207], v[236:239], v[56:59]
  v_exp_f32 v51, v51
  v_mfma_f32_16x16x32_bf16 v[60:63], a[204:207], v[252:255], v[156:159]
  ds_read_b64_tr_b16 a[160:161], v176 offset:0
  v_cvt_pk_bf16_f32 v116, v48, v49
  v_mfma_f32_16x16x32_bf16 v[60:63], a[200:203], v[248:251], v[60:63]
  ds_read_b64_tr_b16 a[162:163], v176 offset:1024
  v_cvt_pk_bf16_f32 v117, v50, v51
  v_mfma_f32_16x16x32_bf16 v[60:63], a[196:199], v[244:247], v[60:63]
  ds_read_b64_tr_b16 a[164:165], v176 offset:2048
  v_mfma_f32_16x16x32_bf16 v[60:63], a[192:195], v[240:243], v[60:63]
  s_waitcnt lgkmcnt(3)
  ds_read_b64_tr_b16 a[166:167], v176 offset:3072
  v_mfma_f32_16x16x32_bf16 v[64:67], a[208:211], v[192:195], v[144:147]
  ds_read_b64_tr_b16 a[168:169], v177 offset:0
  v_mfma_f32_16x16x32_bf16 v[64:67], a[212:215], v[196:199], v[64:67]
  s_waitcnt vmcnt(0)
  ds_read_b64_tr_b16 a[170:171], v177 offset:1024
  v_mfma_f32_16x16x32_bf16 v[64:67], a[216:219], v[200:203], v[64:67]
  s_barrier
  v_mfma_f32_16x16x32_bf16 v[64:67], a[220:223], v[204:207], v[64:67]
  ds_read_b64_tr_b16 a[172:173], v177 offset:2048
  v_mfma_f32_16x16x32_bf16 v[68:71], a[220:223], v[220:223], v[148:151]
  ds_read_b64_tr_b16 v[192:193], v172 offset:16384
  v_mfma_f32_16x16x32_bf16 v[68:71], a[216:219], v[216:219], v[68:71]
  ds_read_b64_tr_b16 v[194:195], v172 offset:17408
  v_mfma_f32_16x16x32_bf16 v[68:71], a[212:215], v[212:215], v[68:71]
  ds_read_b64_tr_b16 v[196:197], v172 offset:18432
  v_mfma_f32_16x16x32_bf16 v[68:71], a[208:211], v[208:211], v[68:71]
  ds_read_b64_tr_b16 v[198:199], v172 offset:19456
  v_mfma_f32_16x16x32_bf16 v[72:75], a[208:211], v[224:227], v[152:155]
  v_exp_f32 v64, v64
  v_mfma_f32_16x16x32_bf16 v[72:75], a[212:215], v[228:231], v[72:75]
  v_exp_f32 v65, v65
  v_mfma_f32_16x16x32_bf16 v[72:75], a[216:219], v[232:235], v[72:75]
  v_exp_f32 v66, v66
  v_mfma_f32_16x16x32_bf16 v[72:75], a[220:223], v[236:239], v[72:75]
  v_exp_f32 v67, v67
  v_mfma_f32_16x16x32_bf16 v[76:79], a[220:223], v[252:255], v[156:159]
  ds_read_b64_tr_b16 v[200:201], v173 offset:16384
  v_cvt_pk_bf16_f32 v118, v64, v65
  v_mfma_f32_16x16x32_bf16 v[76:79], a[216:219], v[248:251], v[76:79]
  ds_read_b64_tr_b16 v[202:203], v173 offset:17408
  v_cvt_pk_bf16_f32 v119, v66, v67
  v_mfma_f32_16x16x32_bf16 v[76:79], a[212:215], v[244:247], v[76:79]
  ds_read_b64_tr_b16 v[204:205], v173 offset:18432
  v_mfma_f32_16x16x32_bf16 v[76:79], a[208:211], v[240:243], v[76:79]
  ds_read_b64_tr_b16 v[206:207], v173 offset:19456
  v_smfmac_f32_16x16x64_bf16 a[224:227], a[240:243], v[80:87], v189
  ds_read_b64_tr_b16 v[208:209], v174 offset:16384
  ds_read_b64_tr_b16 v[210:211], v174 offset:17408
  v_smfmac_f32_16x16x64_bf16 a[224:227], a[240:243], v[112:119], v189
  ds_read_b64_tr_b16 v[212:213], v174 offset:18432
  ds_read_b64_tr_b16 v[214:215], v174 offset:19456
  v_mfma_f32_16x16x32_bf16 a[0:3], a[128:131], v[80:83], a[0:3]
  v_mfma_f32_16x16x32_bf16 a[0:3], a[132:135], v[84:87], a[0:3]
  ds_read_b64_tr_b16 v[216:217], v175 offset:16384
  ds_read_b64_tr_b16 v[218:219], v175 offset:17408
  ds_read_b64_tr_b16 v[220:221], v175 offset:18432
  ds_read_b64_tr_b16 v[222:223], v175 offset:19456
  v_exp_f32 v20, v20
  s_waitcnt lgkmcnt(14)
  v_mfma_f32_16x16x32_bf16 a[0:3], v[192:195], v[112:115], a[0:3]
  v_exp_f32 v21, v21
  s_waitcnt lgkmcnt(12)
  v_mfma_f32_16x16x32_bf16 a[0:3], v[196:199], v[116:119], a[0:3]
  v_exp_f32 v22, v22
  v_exp_f32 v23, v23
  v_cvt_pk_bf16_f32 v120, v20, v21
  v_cvt_pk_bf16_f32 v121, v22, v23
  v_accvgpr_read_b32 v144, a224
  v_accvgpr_read_b32 v145, a225
  v_add_f32 v144, v144, v145
  v_rcp_f32 v144, v144
  s_nop 0
  v_mul_f32 v145, s43, v144
  s_waitcnt lgkmcnt(8)
  v_mfma_f32_16x16x32_bf16 a[16:19], v[204:207], v[116:119], a[16:19]
  v_mfma_f32_16x16x32_bf16 a[16:19], v[200:203], v[112:115], a[16:19]
  ds_read_b64_tr_b16 v[224:225], v176 offset:16384
  ds_read_b64_tr_b16 v[226:227], v176 offset:17408
  ds_read_b64_tr_b16 v[228:229], v176 offset:18432
  ds_read_b64_tr_b16 v[230:231], v176 offset:19456
  v_exp_f32 v36, v36
  v_mfma_f32_16x16x32_bf16 a[16:19], a[140:143], v[84:87], a[16:19]
  v_exp_f32 v37, v37
  v_mfma_f32_16x16x32_bf16 a[16:19], a[136:139], v[80:83], a[16:19]
  v_accvgpr_read_b32 v4, a0
  v_accvgpr_read_b32 v5, a1
  v_accvgpr_read_b32 v6, a2
  v_accvgpr_read_b32 v7, a3
  v_cvt_pk_bf16_f32 v122, v36, v37
  v_pk_fma_f32 v[4:5], v[4:5], v[144:145], v[144:145] op_sel:[0,0,1] op_sel_hi:[1,0,1]
  v_pk_fma_f32 v[6:7], v[6:7], v[144:145], v[144:145] op_sel:[0,0,1] op_sel_hi:[1,0,1]
  v_cvt_pk_bf16_f32 v12, v4, v5
  v_cvt_pk_bf16_f32 v13, v6, v7
  v_max3_f32 v146, |v4|, |v5|, |v6|
  v_max_f32_e64 v146, v146, |v7|
  v_mfma_f32_16x16x32_bf16 a[32:35], a[144:147], v[80:83], a[32:35]
  ds_write_b64 v160, v[12:13] offset:0
  v_mfma_f32_16x16x32_bf16 a[32:35], a[148:151], v[84:87], a[32:35]
  ds_read_b64_tr_b16 a[174:175], v177 offset:3072
  ds_read_b64_tr_b16 v[232:233], v177 offset:16384
  ds_read_b64_tr_b16 v[234:235], v177 offset:17408
  ds_read_b64_tr_b16 v[236:237], v177 offset:18432
  v_exp_f32 v38, v38
  s_waitcnt lgkmcnt(14)
  v_mfma_f32_16x16x32_bf16 a[32:35], v[208:211], v[112:115], a[32:35]
  ds_read_b64_tr_b16 v[238:239], v177 offset:19456
  v_exp_f32 v39, v39
  s_waitcnt lgkmcnt(14)
  v_mfma_f32_16x16x32_bf16 a[32:35], v[212:215], v[116:119], a[32:35]
  v_accvgpr_read_b32 v8, a16
  v_accvgpr_read_b32 v9, a17
  v_accvgpr_read_b32 v10, a18
  v_accvgpr_read_b32 v11, a19
  v_cvt_pk_bf16_f32 v123, v38, v39
  v_pk_fma_f32 v[8:9], v[8:9], v[144:145], v[144:145] op_sel:[0,0,1] op_sel_hi:[1,0,1]
  v_pk_fma_f32 v[10:11], v[10:11], v[144:145], v[144:145] op_sel:[0,0,1] op_sel_hi:[1,0,1]
  v_cvt_pk_bf16_f32 v14, v8, v9
  v_cvt_pk_bf16_f32 v15, v10, v11
  v_max3_f32 v146, v146, |v8|, |v9|
  v_max3_f32 v146, v146, |v10|, |v11|
  v_fma_f32 v146, v146, s35, v145
  s_waitcnt lgkmcnt(10)
  v_mfma_f32_16x16x32_bf16 a[48:51], v[220:223], v[116:119], a[48:51]
  ds_write_b64 v161, v[14:15] offset:0
  v_mfma_f32_16x16x32_bf16 a[48:51], v[216:219], v[112:115], a[48:51]
  ds_read_b64_tr_b16 a[176:177], v178 offset:0
  ds_read_b64_tr_b16 a[178:179], v178 offset:1024
  ds_read_b64_tr_b16 a[180:181], v178 offset:2048
  ds_read_b64_tr_b16 a[182:183], v178 offset:3072
  v_exp_f32 v52, v52
  v_mfma_f32_16x16x32_bf16 a[48:51], a[156:159], v[84:87], a[48:51]
  ds_read_b64_tr_b16 v[240:241], v178 offset:16384
  ds_read_b64_tr_b16 v[242:243], v178 offset:17408
  ds_read_b64_tr_b16 v[244:245], v178 offset:18432
  ds_read_b64_tr_b16 v[246:247], v178 offset:19456
  v_exp_f32 v53, v53
  v_mfma_f32_16x16x32_bf16 a[48:51], a[152:155], v[80:83], a[48:51]
  v_accvgpr_read_b32 v4, a32
  v_accvgpr_read_b32 v5, a33
  v_accvgpr_read_b32 v6, a34
  v_accvgpr_read_b32 v7, a35
  v_cvt_pk_bf16_f32 v124, v52, v53
  v_pk_fma_f32 v[4:5], v[4:5], v[144:145], v[144:145] op_sel:[0,0,1] op_sel_hi:[1,0,1]
  v_pk_fma_f32 v[6:7], v[6:7], v[144:145], v[144:145] op_sel:[0,0,1] op_sel_hi:[1,0,1]
  v_cvt_pk_bf16_f32 v12, v4, v5
  v_cvt_pk_bf16_f32 v13, v6, v7
  v_mfma_f32_16x16x32_bf16 a[64:67], a[160:163], v[80:83], a[64:67]
  ds_write_b64 v162, v[12:13] offset:0
  v_mfma_f32_16x16x32_bf16 a[64:67], a[164:167], v[84:87], a[64:67]
  ds_read_b64_tr_b16 a[184:185], v179 offset:0
  ds_read_b64_tr_b16 a[186:187], v179 offset:1024
  ds_read_b64_tr_b16 a[188:189], v179 offset:2048
  ds_read_b64_tr_b16 a[190:191], v179 offset:3072
  v_exp_f32 v54, v54
  s_waitcnt lgkmcnt(14)
  v_mfma_f32_16x16x32_bf16 a[64:67], v[224:227], v[112:115], a[64:67]
  ds_read_b64_tr_b16 v[248:249], v179 offset:16384
  ds_read_b64_tr_b16 v[250:251], v179 offset:17408
  ds_read_b64_tr_b16 v[252:253], v179 offset:18432
  ds_read_b64_tr_b16 v[254:255], v179 offset:19456
  v_exp_f32 v55, v55
  v_mfma_f32_16x16x32_bf16 a[64:67], v[228:231], v[116:119], a[64:67]
  v_accvgpr_read_b32 v8, a48
  v_accvgpr_read_b32 v9, a49
  v_accvgpr_read_b32 v10, a50
  v_accvgpr_read_b32 v11, a51
  v_cvt_pk_bf16_f32 v125, v54, v55
  v_pk_fma_f32 v[8:9], v[8:9], v[144:145], v[144:145] op_sel:[0,0,1] op_sel_hi:[1,0,1]
  v_pk_fma_f32 v[10:11], v[10:11], v[144:145], v[144:145] op_sel:[0,0,1] op_sel_hi:[1,0,1]
  v_cvt_pk_bf16_f32 v14, v8, v9
  v_cvt_pk_bf16_f32 v15, v10, v11
  v_mfma_f32_16x16x32_bf16 a[80:83], v[236:239], v[116:119], a[80:83]
  ds_write_b64 v163, v[14:15] offset:0
  v_mfma_f32_16x16x32_bf16 a[80:83], v[232:235], v[112:115], a[80:83]
  v_exp_f32 v68, v68
  v_mfma_f32_16x16x32_bf16 a[80:83], a[172:175], v[84:87], a[80:83]
  v_exp_f32 v69, v69
  v_mfma_f32_16x16x32_bf16 a[80:83], a[168:171], v[80:83], a[80:83]
  v_accvgpr_read_b32 v4, a64
  v_accvgpr_read_b32 v5, a65
  v_accvgpr_read_b32 v6, a66
  v_accvgpr_read_b32 v7, a67
  v_cvt_pk_bf16_f32 v126, v68, v69
  v_pk_fma_f32 v[4:5], v[4:5], v[144:145], v[144:145] op_sel:[0,0,1] op_sel_hi:[1,0,1]
  v_pk_fma_f32 v[6:7], v[6:7], v[144:145], v[144:145] op_sel:[0,0,1] op_sel_hi:[1,0,1]
  v_cvt_pk_bf16_f32 v12, v4, v5
  v_cvt_pk_bf16_f32 v13, v6, v7
  s_waitcnt lgkmcnt(14)
  v_mfma_f32_16x16x32_bf16 a[96:99], a[176:179], v[80:83], a[96:99]
  ds_write_b64 v164, v[12:13] offset:0
  v_mfma_f32_16x16x32_bf16 a[96:99], a[180:183], v[84:87], a[96:99]
  v_exp_f32 v70, v70
  s_waitcnt lgkmcnt(13)
  v_mfma_f32_16x16x32_bf16 a[96:99], v[240:243], v[112:115], a[96:99]
  v_exp_f32 v71, v71
  s_waitcnt lgkmcnt(11)
  v_mfma_f32_16x16x32_bf16 a[96:99], v[244:247], v[116:119], a[96:99]
  v_accvgpr_read_b32 v8, a80
  v_accvgpr_read_b32 v9, a81
  v_accvgpr_read_b32 v10, a82
  v_accvgpr_read_b32 v11, a83
  v_cvt_pk_bf16_f32 v127, v70, v71
  v_pk_fma_f32 v[8:9], v[8:9], v[144:145], v[144:145] op_sel:[0,0,1] op_sel_hi:[1,0,1]
  v_pk_fma_f32 v[10:11], v[10:11], v[144:145], v[144:145] op_sel:[0,0,1] op_sel_hi:[1,0,1]
  v_smfmac_f32_16x16x64_bf16 a[228:231], a[240:243], v[88:95], v189
  v_cvt_pk_bf16_f32 v14, v8, v9
  v_smfmac_f32_16x16x64_bf16 a[228:231], a[240:243], v[120:127], v189
  v_cvt_pk_bf16_f32 v15, v10, v11
  s_waitcnt lgkmcnt(2)
  v_mfma_f32_16x16x32_bf16 a[112:115], v[252:255], v[116:119], a[112:115]
  ds_write_b64 v165, v[14:15] offset:0
  v_mfma_f32_16x16x32_bf16 a[112:115], v[248:251], v[112:115], a[112:115]
  v_exp_f32 v24, v24
  v_mfma_f32_16x16x32_bf16 a[112:115], a[188:191], v[84:87], a[112:115]
  v_exp_f32 v25, v25
  v_mfma_f32_16x16x32_bf16 a[112:115], a[184:187], v[80:83], a[112:115]
  v_accvgpr_read_b32 v4, a96
  v_accvgpr_read_b32 v5, a97
  v_accvgpr_read_b32 v6, a98
  v_accvgpr_read_b32 v7, a99
  v_cvt_pk_bf16_f32 v128, v24, v25
  v_accvgpr_read_b32 v148, a228
  v_accvgpr_read_b32 v149, a229
  v_add_f32 v148, v148, v149
  v_rcp_f32 v148, v148
  s_nop 0
  v_mul_f32 v149, s43, v148
  v_pk_fma_f32 v[4:5], v[4:5], v[144:145], v[144:145] op_sel:[0,0,1] op_sel_hi:[1,0,1]
  v_pk_fma_f32 v[6:7], v[6:7], v[144:145], v[144:145] op_sel:[0,0,1] op_sel_hi:[1,0,1]
  v_cvt_pk_bf16_f32 v12, v4, v5
  v_cvt_pk_bf16_f32 v13, v6, v7
  v_mfma_f32_16x16x32_bf16 a[4:7], a[128:131], v[88:91], a[4:7]
  ds_write_b64 v166, v[12:13] offset:0
  v_mfma_f32_16x16x32_bf16 a[4:7], a[132:135], v[92:95], a[4:7]
  v_exp_f32 v26, v26
  v_mfma_f32_16x16x32_bf16 a[4:7], v[192:195], v[120:123], a[4:7]
  v_exp_f32 v27, v27
  v_mfma_f32_16x16x32_bf16 a[4:7], v[196:199], v[124:127], a[4:7]
  v_accvgpr_read_b32 v8, a112
  v_accvgpr_read_b32 v9, a113
  v_accvgpr_read_b32 v10, a114
  v_accvgpr_read_b32 v11, a115
  v_cvt_pk_bf16_f32 v129, v26, v27
  v_pk_fma_f32 v[8:9], v[8:9], v[144:145], v[144:145] op_sel:[0,0,1] op_sel_hi:[1,0,1]
  v_pk_fma_f32 v[10:11], v[10:11], v[144:145], v[144:145] op_sel:[0,0,1] op_sel_hi:[1,0,1]
  v_cvt_pk_bf16_f32 v14, v8, v9
  v_cvt_pk_bf16_f32 v15, v10, v11
  v_mfma_f32_16x16x32_bf16 a[20:23], v[204:207], v[124:127], a[20:23]
  ds_write_b64 v167, v[14:15] offset:0
  ds_read_b128 v[16:19], v182 offset:0
  ds_read_b128 v[32:35], v183 offset:1024
  ds_read_b128 v[48:51], v190 offset:2048
  ds_read_b128 v[64:67], v191 offset:3072
  v_mfma_f32_16x16x32_bf16 a[20:23], v[200:203], v[120:123], a[20:23]
  v_exp_f32 v40, v40
  v_mfma_f32_16x16x32_bf16 a[20:23], a[140:143], v[92:95], a[20:23]
  v_exp_f32 v41, v41
  v_mfma_f32_16x16x32_bf16 a[20:23], a[136:139], v[88:91], a[20:23]
  v_accvgpr_read_b32 v4, a4
  v_accvgpr_read_b32 v5, a5
  v_accvgpr_read_b32 v6, a6
  v_accvgpr_read_b32 v7, a7
  v_cvt_pk_bf16_f32 v130, v40, v41
  v_pk_fma_f32 v[4:5], v[4:5], v[148:149], v[148:149] op_sel:[0,0,1] op_sel_hi:[1,0,1]
  v_pk_fma_f32 v[6:7], v[6:7], v[148:149], v[148:149] op_sel:[0,0,1] op_sel_hi:[1,0,1]
  v_cvt_pk_bf16_f32 v12, v4, v5
  v_cvt_pk_bf16_f32 v13, v6, v7
  v_max3_f32 v150, |v4|, |v5|, |v6|
  v_max_f32_e64 v150, v150, |v7|
  v_mfma_f32_16x16x32_bf16 a[36:39], a[144:147], v[88:91], a[36:39]
  ds_write_b64 v160, v[12:13] offset:16384
  v_mfma_f32_16x16x32_bf16 a[36:39], a[148:151], v[92:95], a[36:39]
  v_exp_f32 v42, v42
  v_mfma_f32_16x16x32_bf16 a[36:39], v[208:211], v[120:123], a[36:39]
  v_exp_f32 v43, v43
  v_mfma_f32_16x16x32_bf16 a[36:39], v[212:215], v[124:127], a[36:39]
  v_accvgpr_read_b32 v8, a20
  v_accvgpr_read_b32 v9, a21
  v_accvgpr_read_b32 v10, a22
  v_accvgpr_read_b32 v11, a23
  v_cvt_pk_bf16_f32 v131, v42, v43
  v_pk_fma_f32 v[8:9], v[8:9], v[148:149], v[148:149] op_sel:[0,0,1] op_sel_hi:[1,0,1]
  v_pk_fma_f32 v[10:11], v[10:11], v[148:149], v[148:149] op_sel:[0,0,1] op_sel_hi:[1,0,1]
  v_cvt_pk_bf16_f32 v14, v8, v9
  v_cvt_pk_bf16_f32 v15, v10, v11
  v_max3_f32 v150, v150, |v8|, |v9|
  v_max3_f32 v150, v150, |v10|, |v11|
  v_fma_f32 v150, v150, s35, v149
  v_mfma_f32_16x16x32_bf16 a[52:55], v[220:223], v[124:127], a[52:55]
  ds_write_b64 v161, v[14:15] offset:16384
  s_waitcnt lgkmcnt(5)
  buffer_store_dwordx4 v[16:19], v184, s[24:27], s44 offen offset:0 sc1 nt
  v_mfma_f32_16x16x32_bf16 a[52:55], v[216:219], v[120:123], a[52:55]
  v_exp_f32 v56, v56
  v_mfma_f32_16x16x32_bf16 a[52:55], a[156:159], v[92:95], a[52:55]
  v_exp_f32 v57, v57
  v_mfma_f32_16x16x32_bf16 a[52:55], a[152:155], v[88:91], a[52:55]
  v_accvgpr_read_b32 v4, a36
  v_accvgpr_read_b32 v5, a37
  v_accvgpr_read_b32 v6, a38
  v_accvgpr_read_b32 v7, a39
  v_cvt_pk_bf16_f32 v132, v56, v57
  v_pk_fma_f32 v[4:5], v[4:5], v[148:149], v[148:149] op_sel:[0,0,1] op_sel_hi:[1,0,1]
  v_pk_fma_f32 v[6:7], v[6:7], v[148:149], v[148:149] op_sel:[0,0,1] op_sel_hi:[1,0,1]
  v_cvt_pk_bf16_f32 v12, v4, v5
  v_cvt_pk_bf16_f32 v13, v6, v7
  v_mfma_f32_16x16x32_bf16 a[68:71], a[160:163], v[88:91], a[68:71]
  ds_write_b64 v162, v[12:13] offset:16384
  s_waitcnt lgkmcnt(5)
  buffer_store_dwordx4 v[32:35], v184, s[24:27], s44 offen offset:1024 sc1 nt
  v_mfma_f32_16x16x32_bf16 a[68:71], a[164:167], v[92:95], a[68:71]
  v_exp_f32 v58, v58
  v_mfma_f32_16x16x32_bf16 a[68:71], v[224:227], v[120:123], a[68:71]
  v_exp_f32 v59, v59
  v_mfma_f32_16x16x32_bf16 a[68:71], v[228:231], v[124:127], a[68:71]
  v_accvgpr_read_b32 v8, a52
  v_accvgpr_read_b32 v9, a53
  v_accvgpr_read_b32 v10, a54
  v_accvgpr_read_b32 v11, a55
  v_cvt_pk_bf16_f32 v133, v58, v59
  v_pk_fma_f32 v[8:9], v[8:9], v[148:149], v[148:149] op_sel:[0,0,1] op_sel_hi:[1,0,1]
  v_pk_fma_f32 v[10:11], v[10:11], v[148:149], v[148:149] op_sel:[0,0,1] op_sel_hi:[1,0,1]
  v_cvt_pk_bf16_f32 v14, v8, v9
  v_cvt_pk_bf16_f32 v15, v10, v11
  v_mfma_f32_16x16x32_bf16 a[84:87], v[236:239], v[124:127], a[84:87]
  ds_write_b64 v163, v[14:15] offset:16384
  s_waitcnt lgkmcnt(5)
  buffer_store_dwordx4 v[48:51], v184, s[24:27], s44 offen offset:2048 sc1 nt
  v_mfma_f32_16x16x32_bf16 a[84:87], v[232:235], v[120:123], a[84:87]
  v_exp_f32 v72, v72
  v_mfma_f32_16x16x32_bf16 a[84:87], a[172:175], v[92:95], a[84:87]
  v_exp_f32 v73, v73
  v_mfma_f32_16x16x32_bf16 a[84:87], a[168:171], v[88:91], a[84:87]
  v_accvgpr_read_b32 v4, a68
  v_accvgpr_read_b32 v5, a69
  v_accvgpr_read_b32 v6, a70
  v_accvgpr_read_b32 v7, a71
  v_cvt_pk_bf16_f32 v134, v72, v73
  v_pk_fma_f32 v[4:5], v[4:5], v[148:149], v[148:149] op_sel:[0,0,1] op_sel_hi:[1,0,1]
  v_pk_fma_f32 v[6:7], v[6:7], v[148:149], v[148:149] op_sel:[0,0,1] op_sel_hi:[1,0,1]
  v_cvt_pk_bf16_f32 v12, v4, v5
  v_cvt_pk_bf16_f32 v13, v6, v7
  v_mfma_f32_16x16x32_bf16 a[100:103], a[176:179], v[88:91], a[100:103]
  ds_write_b64 v164, v[12:13] offset:16384
  s_waitcnt lgkmcnt(5)
  buffer_store_dwordx4 v[64:67], v184, s[24:27], s44 offen offset:3072 sc1 nt
  v_mfma_f32_16x16x32_bf16 a[100:103], a[180:183], v[92:95], a[100:103]
  v_exp_f32 v74, v74
  v_mfma_f32_16x16x32_bf16 a[100:103], v[240:243], v[120:123], a[100:103]
  v_exp_f32 v75, v75
  v_mfma_f32_16x16x32_bf16 a[100:103], v[244:247], v[124:127], a[100:103]
  v_accvgpr_read_b32 v8, a84
  v_accvgpr_read_b32 v9, a85
  v_accvgpr_read_b32 v10, a86
  v_accvgpr_read_b32 v11, a87
  v_cvt_pk_bf16_f32 v135, v74, v75
  v_pk_fma_f32 v[8:9], v[8:9], v[148:149], v[148:149] op_sel:[0,0,1] op_sel_hi:[1,0,1]
  v_pk_fma_f32 v[10:11], v[10:11], v[148:149], v[148:149] op_sel:[0,0,1] op_sel_hi:[1,0,1]
  v_smfmac_f32_16x16x64_bf16 a[232:235], a[240:243], v[96:103], v189
  v_cvt_pk_bf16_f32 v14, v8, v9
  v_smfmac_f32_16x16x64_bf16 a[232:235], a[240:243], v[128:135], v189
  v_cvt_pk_bf16_f32 v15, v10, v11
  v_mfma_f32_16x16x32_bf16 a[116:119], v[252:255], v[124:127], a[116:119]
  ds_write_b64 v165, v[14:15] offset:16384
  v_mfma_f32_16x16x32_bf16 a[116:119], v[248:251], v[120:123], a[116:119]
  v_exp_f32 v28, v28
  v_mfma_f32_16x16x32_bf16 a[116:119], a[188:191], v[92:95], a[116:119]
  v_exp_f32 v29, v29
  v_mfma_f32_16x16x32_bf16 a[116:119], a[184:187], v[88:91], a[116:119]
  v_accvgpr_read_b32 v4, a100
  v_accvgpr_read_b32 v5, a101
  v_accvgpr_read_b32 v6, a102
  v_accvgpr_read_b32 v7, a103
  v_cvt_pk_bf16_f32 v136, v28, v29
  v_accvgpr_read_b32 v152, a232
  v_accvgpr_read_b32 v153, a233
  v_add_f32 v152, v152, v153
  v_rcp_f32 v152, v152
  s_nop 0
  v_mul_f32 v153, s43, v152
  v_pk_fma_f32 v[4:5], v[4:5], v[148:149], v[148:149] op_sel:[0,0,1] op_sel_hi:[1,0,1]
  v_pk_fma_f32 v[6:7], v[6:7], v[148:149], v[148:149] op_sel:[0,0,1] op_sel_hi:[1,0,1]
  v_cvt_pk_bf16_f32 v12, v4, v5
  v_cvt_pk_bf16_f32 v13, v6, v7
  v_mfma_f32_16x16x32_bf16 a[8:11], a[128:131], v[96:99], a[8:11]
  ds_write_b64 v166, v[12:13] offset:16384
  v_mfma_f32_16x16x32_bf16 a[8:11], a[132:135], v[100:103], a[8:11]
  v_exp_f32 v30, v30
  v_mfma_f32_16x16x32_bf16 a[8:11], v[192:195], v[128:131], a[8:11]
  v_exp_f32 v31, v31
  v_mfma_f32_16x16x32_bf16 a[8:11], v[196:199], v[132:135], a[8:11]
  v_accvgpr_read_b32 v8, a116
  v_accvgpr_read_b32 v9, a117
  v_accvgpr_read_b32 v10, a118
  v_accvgpr_read_b32 v11, a119
  v_cvt_pk_bf16_f32 v137, v30, v31
  v_pk_fma_f32 v[8:9], v[8:9], v[148:149], v[148:149] op_sel:[0,0,1] op_sel_hi:[1,0,1]
  v_pk_fma_f32 v[10:11], v[10:11], v[148:149], v[148:149] op_sel:[0,0,1] op_sel_hi:[1,0,1]
  v_cvt_pk_bf16_f32 v14, v8, v9
  v_cvt_pk_bf16_f32 v15, v10, v11
  v_mfma_f32_16x16x32_bf16 a[24:27], v[204:207], v[132:135], a[24:27]
  ds_write_b64 v167, v[14:15] offset:16384
  ds_read_b128 v[20:23], v182 offset:16384
  ds_read_b128 v[36:39], v183 offset:17408
  ds_read_b128 v[52:55], v190 offset:18432
  ds_read_b128 v[68:71], v191 offset:19456
  v_mfma_f32_16x16x32_bf16 a[24:27], v[200:203], v[128:131], a[24:27]
  v_exp_f32 v44, v44
  v_mfma_f32_16x16x32_bf16 a[24:27], a[140:143], v[100:103], a[24:27]
  v_exp_f32 v45, v45
  v_mfma_f32_16x16x32_bf16 a[24:27], a[136:139], v[96:99], a[24:27]
  v_accvgpr_read_b32 v4, a8
  v_accvgpr_read_b32 v5, a9
  v_accvgpr_read_b32 v6, a10
  v_accvgpr_read_b32 v7, a11
  v_cvt_pk_bf16_f32 v138, v44, v45
  v_pk_fma_f32 v[4:5], v[4:5], v[152:153], v[152:153] op_sel:[0,0,1] op_sel_hi:[1,0,1]
  v_pk_fma_f32 v[6:7], v[6:7], v[152:153], v[152:153] op_sel:[0,0,1] op_sel_hi:[1,0,1]
  v_cvt_pk_bf16_f32 v12, v4, v5
  v_cvt_pk_bf16_f32 v13, v6, v7
  v_max3_f32 v154, |v4|, |v5|, |v6|
  v_max_f32_e64 v154, v154, |v7|
  v_mfma_f32_16x16x32_bf16 a[40:43], a[144:147], v[96:99], a[40:43]
  ds_write_b64 v160, v[12:13] offset:32768
  v_mfma_f32_16x16x32_bf16 a[40:43], a[148:151], v[100:103], a[40:43]
  v_exp_f32 v46, v46
  v_mfma_f32_16x16x32_bf16 a[40:43], v[208:211], v[128:131], a[40:43]
  v_exp_f32 v47, v47
  v_mfma_f32_16x16x32_bf16 a[40:43], v[212:215], v[132:135], a[40:43]
  v_accvgpr_read_b32 v8, a24
  v_accvgpr_read_b32 v9, a25
  v_accvgpr_read_b32 v10, a26
  v_accvgpr_read_b32 v11, a27
  v_cvt_pk_bf16_f32 v139, v46, v47
  v_pk_fma_f32 v[8:9], v[8:9], v[152:153], v[152:153] op_sel:[0,0,1] op_sel_hi:[1,0,1]
  v_pk_fma_f32 v[10:11], v[10:11], v[152:153], v[152:153] op_sel:[0,0,1] op_sel_hi:[1,0,1]
  v_cvt_pk_bf16_f32 v14, v8, v9
  v_cvt_pk_bf16_f32 v15, v10, v11
  v_max3_f32 v154, v154, |v8|, |v9|
  v_max3_f32 v154, v154, |v10|, |v11|
  v_fma_f32 v154, v154, s35, v153
  v_mfma_f32_16x16x32_bf16 a[56:59], v[220:223], v[132:135], a[56:59]
  ds_write_b64 v161, v[14:15] offset:32768
  s_waitcnt lgkmcnt(5)
  buffer_store_dwordx4 v[20:23], v184, s[24:27], s45 offen offset:0 sc1 nt
  v_mfma_f32_16x16x32_bf16 a[56:59], v[216:219], v[128:131], a[56:59]
  v_exp_f32 v60, v60
  v_mfma_f32_16x16x32_bf16 a[56:59], a[156:159], v[100:103], a[56:59]
  v_exp_f32 v61, v61
  v_mfma_f32_16x16x32_bf16 a[56:59], a[152:155], v[96:99], a[56:59]
  v_accvgpr_read_b32 v4, a40
  v_accvgpr_read_b32 v5, a41
  v_accvgpr_read_b32 v6, a42
  v_accvgpr_read_b32 v7, a43
  v_cvt_pk_bf16_f32 v140, v60, v61
  v_pk_fma_f32 v[4:5], v[4:5], v[152:153], v[152:153] op_sel:[0,0,1] op_sel_hi:[1,0,1]
  v_pk_fma_f32 v[6:7], v[6:7], v[152:153], v[152:153] op_sel:[0,0,1] op_sel_hi:[1,0,1]
  v_cvt_pk_bf16_f32 v12, v4, v5
  v_cvt_pk_bf16_f32 v13, v6, v7
  v_mfma_f32_16x16x32_bf16 a[72:75], a[160:163], v[96:99], a[72:75]
  ds_write_b64 v162, v[12:13] offset:32768
  s_waitcnt lgkmcnt(5)
  buffer_store_dwordx4 v[36:39], v184, s[24:27], s45 offen offset:1024 sc1 nt
  v_mfma_f32_16x16x32_bf16 a[72:75], a[164:167], v[100:103], a[72:75]
  v_exp_f32 v62, v62
  v_mfma_f32_16x16x32_bf16 a[72:75], v[224:227], v[128:131], a[72:75]
  v_exp_f32 v63, v63
  v_mfma_f32_16x16x32_bf16 a[72:75], v[228:231], v[132:135], a[72:75]
  v_accvgpr_read_b32 v8, a56
  v_accvgpr_read_b32 v9, a57
  v_accvgpr_read_b32 v10, a58
  v_accvgpr_read_b32 v11, a59
  v_cvt_pk_bf16_f32 v141, v62, v63
  v_pk_fma_f32 v[8:9], v[8:9], v[152:153], v[152:153] op_sel:[0,0,1] op_sel_hi:[1,0,1]
  v_pk_fma_f32 v[10:11], v[10:11], v[152:153], v[152:153] op_sel:[0,0,1] op_sel_hi:[1,0,1]
  v_cvt_pk_bf16_f32 v14, v8, v9
  v_cvt_pk_bf16_f32 v15, v10, v11
  v_mfma_f32_16x16x32_bf16 a[88:91], v[236:239], v[132:135], a[88:91]
  ds_write_b64 v163, v[14:15] offset:32768
  s_waitcnt lgkmcnt(5)
  buffer_store_dwordx4 v[52:55], v184, s[24:27], s45 offen offset:2048 sc1 nt
  v_mfma_f32_16x16x32_bf16 a[88:91], v[232:235], v[128:131], a[88:91]
  v_exp_f32 v76, v76
  v_mfma_f32_16x16x32_bf16 a[88:91], a[172:175], v[100:103], a[88:91]
  v_exp_f32 v77, v77
  v_mfma_f32_16x16x32_bf16 a[88:91], a[168:171], v[96:99], a[88:91]
  v_accvgpr_read_b32 v4, a72
  v_accvgpr_read_b32 v5, a73
  v_accvgpr_read_b32 v6, a74
  v_accvgpr_read_b32 v7, a75
  v_cvt_pk_bf16_f32 v142, v76, v77
  v_pk_fma_f32 v[4:5], v[4:5], v[152:153], v[152:153] op_sel:[0,0,1] op_sel_hi:[1,0,1]
  v_pk_fma_f32 v[6:7], v[6:7], v[152:153], v[152:153] op_sel:[0,0,1] op_sel_hi:[1,0,1]
  v_cvt_pk_bf16_f32 v12, v4, v5
  v_cvt_pk_bf16_f32 v13, v6, v7
  v_mfma_f32_16x16x32_bf16 a[104:107], a[176:179], v[96:99], a[104:107]
  ds_write_b64 v164, v[12:13] offset:32768
  s_waitcnt lgkmcnt(5)
  buffer_store_dwordx4 v[68:71], v184, s[24:27], s45 offen offset:3072 sc1 nt
  v_mfma_f32_16x16x32_bf16 a[104:107], a[180:183], v[100:103], a[104:107]
  v_exp_f32 v78, v78
  v_mfma_f32_16x16x32_bf16 a[104:107], v[240:243], v[128:131], a[104:107]
  v_exp_f32 v79, v79
  v_mfma_f32_16x16x32_bf16 a[104:107], v[244:247], v[132:135], a[104:107]
  v_accvgpr_read_b32 v8, a88
  v_accvgpr_read_b32 v9, a89
  v_accvgpr_read_b32 v10, a90
  v_accvgpr_read_b32 v11, a91
  v_cvt_pk_bf16_f32 v143, v78, v79
  v_pk_fma_f32 v[8:9], v[8:9], v[152:153], v[152:153] op_sel:[0,0,1] op_sel_hi:[1,0,1]
  v_pk_fma_f32 v[10:11], v[10:11], v[152:153], v[152:153] op_sel:[0,0,1] op_sel_hi:[1,0,1]
  v_smfmac_f32_16x16x64_bf16 a[236:239], a[240:243], v[104:111], v189
  v_cvt_pk_bf16_f32 v14, v8, v9
  v_smfmac_f32_16x16x64_bf16 a[236:239], a[240:243], v[136:143], v189
  v_cvt_pk_bf16_f32 v15, v10, v11
  v_mfma_f32_16x16x32_bf16 a[120:123], v[252:255], v[132:135], a[120:123]
  ds_write_b64 v165, v[14:15] offset:32768
  v_mfma_f32_16x16x32_bf16 a[120:123], v[248:251], v[128:131], a[120:123]
  v_accvgpr_read_b32 v4, a104
  v_accvgpr_read_b32 v5, a105
  v_mfma_f32_16x16x32_bf16 a[120:123], a[188:191], v[100:103], a[120:123]
  v_accvgpr_read_b32 v6, a106
  v_accvgpr_read_b32 v7, a107
  v_mfma_f32_16x16x32_bf16 a[120:123], a[184:187], v[96:99], a[120:123]
  s_nop 1
  v_accvgpr_read_b32 v156, a236
  v_accvgpr_read_b32 v157, a237
  v_add_f32 v156, v156, v157
  v_rcp_f32 v156, v156
  s_nop 0
  v_mul_f32 v157, s43, v156
  v_fma_f32 v4, v4, v152, v153
  v_fma_f32 v5, v5, v152, v153
  v_fma_f32 v6, v6, v152, v153
  v_fma_f32 v7, v7, v152, v153
  v_cvt_pk_bf16_f32 v12, v4, v5
  v_cvt_pk_bf16_f32 v13, v6, v7
  v_mfma_f32_16x16x32_bf16 a[12:15], a[128:131], v[104:107], a[12:15]
  ds_write_b64 v166, v[12:13] offset:32768
  v_mfma_f32_16x16x32_bf16 a[12:15], a[132:135], v[108:111], a[12:15]
  v_accvgpr_read_b32 v8, a120
  v_accvgpr_read_b32 v9, a121
  v_mfma_f32_16x16x32_bf16 a[12:15], v[192:195], v[136:139], a[12:15]
  v_accvgpr_read_b32 v10, a122
  v_accvgpr_read_b32 v11, a123
  v_mfma_f32_16x16x32_bf16 a[12:15], v[196:199], v[140:143], a[12:15]
  v_fma_f32 v8, v8, v152, v153
  v_fma_f32 v9, v9, v152, v153
  v_fma_f32 v10, v10, v152, v153
  v_fma_f32 v11, v11, v152, v153
  v_cvt_pk_bf16_f32 v14, v8, v9
  v_cvt_pk_bf16_f32 v15, v10, v11
  v_mfma_f32_16x16x32_bf16 a[28:31], v[204:207], v[140:143], a[28:31]
  ds_write_b64 v167, v[14:15] offset:32768
  ds_read_b128 v[24:27], v182 offset:32768
  ds_read_b128 v[40:43], v183 offset:33792
  ds_read_b128 v[56:59], v190 offset:34816
  ds_read_b128 v[72:75], v191 offset:35840
  v_mfma_f32_16x16x32_bf16 a[28:31], v[200:203], v[136:139], a[28:31]
  v_accvgpr_read_b32 v4, a12
  v_accvgpr_read_b32 v5, a13
  v_mfma_f32_16x16x32_bf16 a[28:31], a[140:143], v[108:111], a[28:31]
  v_accvgpr_read_b32 v6, a14
  v_accvgpr_read_b32 v7, a15
  v_mfma_f32_16x16x32_bf16 a[28:31], a[136:139], v[104:107], a[28:31]
  v_fma_f32 v4, v4, v156, v157
  v_fma_f32 v5, v5, v156, v157
  v_fma_f32 v6, v6, v156, v157
  v_fma_f32 v7, v7, v156, v157
  v_cvt_pk_bf16_f32 v12, v4, v5
  v_cvt_pk_bf16_f32 v13, v6, v7
  v_max3_f32 v158, |v4|, |v5|, |v6|
  v_max_f32_e64 v158, v158, |v7|
  v_mfma_f32_16x16x32_bf16 a[44:47], a[144:147], v[104:107], a[44:47]
  ds_write_b64 v160, v[12:13] offset:49152
  v_mfma_f32_16x16x32_bf16 a[44:47], a[148:151], v[108:111], a[44:47]
  v_accvgpr_read_b32 v8, a28
  v_accvgpr_read_b32 v9, a29
  v_mfma_f32_16x16x32_bf16 a[44:47], v[208:211], v[136:139], a[44:47]
  v_accvgpr_read_b32 v10, a30
  v_accvgpr_read_b32 v11, a31
  v_mfma_f32_16x16x32_bf16 a[44:47], v[212:215], v[140:143], a[44:47]
  s_mov_b32 s36, 0x21800000
  v_min_f32 v3, v144, v148
  s_lshl_b32 s38, s28, 2
  v_min3_f32 v3, v3, v152, v156
  s_add_u32 s38, s38, 131072
  v_cmp_nle_f32 vcc, s36, v3
  v_mov_b32 v2, 131072
  v_mov_b32 v3, s38
  v_fma_f32 v8, v8, v156, v157
  v_fma_f32 v9, v9, v156, v157
  v_fma_f32 v10, v10, v156, v157
  v_fma_f32 v11, v11, v156, v157
  v_cvt_pk_bf16_f32 v14, v8, v9
  v_cvt_pk_bf16_f32 v15, v10, v11
  v_max3_f32 v158, v158, |v8|, |v9|
  v_max3_f32 v158, v158, |v10|, |v11|
  v_fma_f32 v158, v158, s35, v157
  v_min_f32 v1, v146, v150
  v_min3_f32 v1, v1, v154, v158
  v_cmp_nle_f32 s[52:53], 0, v1
  s_nop 1
  s_or_b64 vcc, vcc, s[52:53]
  s_cselect_b32 s37, 1, 0
  v_mov_b32 v1, s37
  v_mfma_f32_16x16x32_bf16 a[60:63], v[220:223], v[140:143], a[60:63]
  ds_write_b64 v161, v[14:15] offset:49152
  s_waitcnt lgkmcnt(5)
  buffer_store_dwordx4 v[24:27], v184, s[24:27], s46 offen offset:0 sc1 nt
  v_mfma_f32_16x16x32_bf16 a[60:63], v[216:219], v[136:139], a[60:63]
  v_accvgpr_read_b32 v4, a44
  v_accvgpr_read_b32 v5, a45
  v_mfma_f32_16x16x32_bf16 a[60:63], a[156:159], v[108:111], a[60:63]
  v_accvgpr_read_b32 v6, a46
  v_accvgpr_read_b32 v7, a47
  v_mfma_f32_16x16x32_bf16 a[60:63], a[152:155], v[104:107], a[60:63]
  ds_write_b32 v3, v1
  v_fma_f32 v4, v4, v156, v157
  v_fma_f32 v5, v5, v156, v157
  v_fma_f32 v6, v6, v156, v157
  v_fma_f32 v7, v7, v156, v157
  v_cvt_pk_bf16_f32 v12, v4, v5
  v_cvt_pk_bf16_f32 v13, v6, v7
  v_mfma_f32_16x16x32_bf16 a[76:79], a[160:163], v[104:107], a[76:79]
  ds_write_b64 v162, v[12:13] offset:49152
  s_waitcnt lgkmcnt(6)
  buffer_store_dwordx4 v[40:43], v184, s[24:27], s46 offen offset:1024 sc1 nt
  v_mfma_f32_16x16x32_bf16 a[76:79], a[164:167], v[108:111], a[76:79]
  v_accvgpr_read_b32 v8, a60
  v_accvgpr_read_b32 v9, a61
  v_mfma_f32_16x16x32_bf16 a[76:79], v[224:227], v[136:139], a[76:79]
  v_accvgpr_read_b32 v10, a62
  v_accvgpr_read_b32 v11, a63
  v_mfma_f32_16x16x32_bf16 a[76:79], v[228:231], v[140:143], a[76:79]
  v_fma_f32 v8, v8, v156, v157
  v_fma_f32 v9, v9, v156, v157
  v_fma_f32 v10, v10, v156, v157
  v_fma_f32 v11, v11, v156, v157
  v_cvt_pk_bf16_f32 v14, v8, v9
  v_cvt_pk_bf16_f32 v15, v10, v11
  v_mfma_f32_16x16x32_bf16 a[92:95], v[236:239], v[140:143], a[92:95]
  ds_write_b64 v163, v[14:15] offset:49152
  s_waitcnt lgkmcnt(6)
  buffer_store_dwordx4 v[56:59], v184, s[24:27], s46 offen offset:2048 sc1 nt
  v_mfma_f32_16x16x32_bf16 a[92:95], v[232:235], v[136:139], a[92:95]
  v_accvgpr_read_b32 v4, a76
  v_accvgpr_read_b32 v5, a77
  v_mfma_f32_16x16x32_bf16 a[92:95], a[172:175], v[108:111], a[92:95]
  v_accvgpr_read_b32 v6, a78
  v_accvgpr_read_b32 v7, a79
  v_mfma_f32_16x16x32_bf16 a[92:95], a[168:171], v[104:107], a[92:95]
  s_waitcnt lgkmcnt(2)
  s_barrier
  ds_read_b128 v[168:171], v2
  v_fma_f32 v4, v4, v156, v157
  v_fma_f32 v5, v5, v156, v157
  v_fma_f32 v6, v6, v156, v157
  v_fma_f32 v7, v7, v156, v157
  v_cvt_pk_bf16_f32 v12, v4, v5
  v_cvt_pk_bf16_f32 v13, v6, v7
  v_mfma_f32_16x16x32_bf16 a[108:111], a[176:179], v[104:107], a[108:111]
  ds_write_b64 v164, v[12:13] offset:49152
  buffer_store_dwordx4 v[72:75], v184, s[24:27], s46 offen offset:3072 sc1 nt
  v_mfma_f32_16x16x32_bf16 a[108:111], a[180:183], v[108:111], a[108:111]
  v_accvgpr_read_b32 v8, a92
  v_accvgpr_read_b32 v9, a93
  v_mfma_f32_16x16x32_bf16 a[108:111], v[240:243], v[136:139], a[108:111]
  v_accvgpr_read_b32 v10, a94
  v_accvgpr_read_b32 v11, a95
  v_mfma_f32_16x16x32_bf16 a[108:111], v[244:247], v[140:143], a[108:111]
  v_fma_f32 v8, v8, v156, v157
  v_fma_f32 v9, v9, v156, v157
  v_fma_f32 v10, v10, v156, v157
  v_fma_f32 v11, v11, v156, v157
  v_cvt_pk_bf16_f32 v14, v8, v9
  v_cvt_pk_bf16_f32 v15, v10, v11
  v_mfma_f32_16x16x32_bf16 a[124:127], v[252:255], v[140:143], a[124:127]
  ds_write_b64 v165, v[14:15] offset:49152
  v_mfma_f32_16x16x32_bf16 a[124:127], v[248:251], v[136:139], a[124:127]
  v_accvgpr_read_b32 v4, a108
  v_accvgpr_read_b32 v5, a109
  v_mfma_f32_16x16x32_bf16 a[124:127], a[188:191], v[108:111], a[124:127]
  v_accvgpr_read_b32 v6, a110
  v_accvgpr_read_b32 v7, a111
  v_mfma_f32_16x16x32_bf16 a[124:127], a[184:187], v[104:107], a[124:127]
  v_fma_f32 v4, v4, v156, v157
  v_fma_f32 v5, v5, v156, v157
  v_fma_f32 v6, v6, v156, v157
  v_fma_f32 v7, v7, v156, v157
  v_cvt_pk_bf16_f32 v12, v4, v5
  v_cvt_pk_bf16_f32 v13, v6, v7
  s_waitcnt lgkmcnt(2)
  v_or_b32 v168, v168, v169
  v_or3_b32 v168, v168, v170, v171
  ds_write_b64 v166, v[12:13] offset:49152
  v_accvgpr_read_b32 v8, a124
  v_accvgpr_read_b32 v9, a125
  v_accvgpr_read_b32 v10, a126
  v_accvgpr_read_b32 v11, a127
  v_pk_fma_f32 v[8:9], v[8:9], v[156:157], v[156:157] op_sel:[0,0,1] op_sel_hi:[1,0,1]
  v_pk_fma_f32 v[10:11], v[10:11], v[156:157], v[156:157] op_sel:[0,0,1] op_sel_hi:[1,0,1]
  v_cvt_pk_bf16_f32 v14, v8, v9
  v_cvt_pk_bf16_f32 v15, v10, v11
  v_readfirstlane_b32 s37, v168
  ds_write_b64 v167, v[14:15] offset:49152
  ds_read_b128 v[28:31], v182 offset:49152
  ds_read_b128 v[44:47], v183 offset:50176
  ds_read_b128 v[60:63], v190 offset:51200
  ds_read_b128 v[76:79], v191 offset:52224
  s_waitcnt lgkmcnt(3)
  buffer_store_dwordx4 v[28:31], v184, s[24:27], s47 offen offset:0 sc1 nt
  s_waitcnt lgkmcnt(2)
  buffer_store_dwordx4 v[44:47], v184, s[24:27], s47 offen offset:1024 sc1 nt
  s_waitcnt lgkmcnt(1)
  buffer_store_dwordx4 v[60:63], v184, s[24:27], s47 offen offset:2048 sc1 nt
  s_waitcnt lgkmcnt(0)
  buffer_store_dwordx4 v[76:79], v184, s[24:27], s47 offen offset:3072 sc1 nt
  s_cmp_gt_u32 s37, s32
  s_cbranch_scc1 L_fallback
L_end:
  s_endpgm
L_codeend:
L_fallback:
  s_waitcnt vmcnt(0) lgkmcnt(0)
  s_mov_b32 s32, 1
  v_and_b32 v2, 63, v0
  v_and_b32 v3, 15, v2
  v_lshrrev_b32 v4, 4, v2
  v_lshrrev_b32 v5, 2, v3
  v_lshlrev_b32 v5, 12, v5
  v_and_b32 v6, 3, v3
  v_lshl_add_u32 v5, v6, 8, v5
  v_add_u32 v6, 0, v4
  v_xor_b32 v6, v6, v3
  v_lshl_add_u32 v168, v6, 4, v5
  v_add_u32 v6, 4, v4
  v_xor_b32 v6, v6, v3
  v_lshl_add_u32 v169, v6, 4, v5
  v_add_u32 v6, 8, v4
  v_xor_b32 v6, v6, v3
  v_lshl_add_u32 v170, v6, 4, v5
  v_add_u32 v6, 12, v4
  v_xor_b32 v6, v6, v3
  v_lshl_add_u32 v171, v6, 4, v5
  v_lshrrev_b32 v5, 2, v3
  v_and_b32 v6, 1, v4
  v_lshl_add_u32 v6, v6, 2, v5
  v_lshl_add_u32 v5, v4, 4, v5
  v_lshlrev_b32 v5, 8, v5
  v_and_b32 v7, 3, v3
  v_lshl_add_u32 v5, v7, 3, v5
  v_add_u32 v5, 65536, v5
  v_xor_b32 v7, 0, v6
  v_lshl_add_u32 v172, v7, 5, v5
  v_xor_b32 v7, 1, v6
  v_lshl_add_u32 v173, v7, 5, v5
  v_xor_b32 v7, 2, v6
  v_lshl_add_u32 v174, v7, 5, v5
  v_xor_b32 v7, 3, v6
  v_lshl_add_u32 v175, v7, 5, v5
  v_xor_b32 v7, 4, v6
  v_lshl_add_u32 v176, v7, 5, v5
  v_xor_b32 v7, 5, v6
  v_lshl_add_u32 v177, v7, 5, v5
  v_xor_b32 v7, 6, v6
  v_lshl_add_u32 v178, v7, 5, v5
  v_xor_b32 v7, 7, v6
  v_lshl_add_u32 v179, v7, 5, v5
  v_lshlrev_b32 v5, 8, v3
  v_lshl_add_u32 v5, v4, 4, v5
  buffer_load_dwordx4 v[192:195], v5, s[12:15], s44 offen offset:0
  buffer_load_dwordx4 v[196:199], v5, s[12:15], s44 offen offset:64
  buffer_load_dwordx4 v[200:203], v5, s[12:15], s44 offen offset:128
  buffer_load_dwordx4 v[204:207], v5, s[12:15], s44 offen offset:192
  buffer_load_dwordx4 v[208:211], v5, s[12:15], s45 offen offset:0
  buffer_load_dwordx4 v[212:215], v5, s[12:15], s45 offen offset:64
  buffer_load_dwordx4 v[216:219], v5, s[12:15], s45 offen offset:128
  buffer_load_dwordx4 v[220:223], v5, s[12:15], s45 offen offset:192
  buffer_load_dwordx4 v[224:227], v5, s[12:15], s46 offen offset:0
  buffer_load_dwordx4 v[228:231], v5, s[12:15], s46 offen offset:64
  buffer_load_dwordx4 v[232:235], v5, s[12:15], s46 offen offset:128
  buffer_load_dwordx4 v[236:239], v5, s[12:15], s46 offen offset:192
  buffer_load_dwordx4 v[240:243], v5, s[12:15], s47 offen offset:0
  buffer_load_dwordx4 v[244:247], v5, s[12:15], s47 offen offset:64
  buffer_load_dwordx4 v[248:251], v5, s[12:15], s47 offen offset:128
  buffer_load_dwordx4 v[252:255], v5, s[12:15], s47 offen offset:192
  s_waitcnt vmcnt(0)
  v_lshlrev_b32 v6, 16, v192
  v_and_b32 v7, s39, v192
  v_pk_mul_f32 v[6:7], v[6:7], s[40:41]
  v_cvt_pk_bf16_f32 v192, v6, v7
  v_lshlrev_b32 v6, 16, v193
  v_and_b32 v7, s39, v193
  v_pk_mul_f32 v[6:7], v[6:7], s[40:41]
  v_cvt_pk_bf16_f32 v193, v6, v7
  v_lshlrev_b32 v6, 16, v194
  v_and_b32 v7, s39, v194
  v_pk_mul_f32 v[6:7], v[6:7], s[40:41]
  v_cvt_pk_bf16_f32 v194, v6, v7
  v_lshlrev_b32 v6, 16, v195
  v_and_b32 v7, s39, v195
  v_pk_mul_f32 v[6:7], v[6:7], s[40:41]
  v_cvt_pk_bf16_f32 v195, v6, v7
  v_lshlrev_b32 v6, 16, v196
  v_and_b32 v7, s39, v196
  v_pk_mul_f32 v[6:7], v[6:7], s[40:41]
  v_cvt_pk_bf16_f32 v196, v6, v7
  v_lshlrev_b32 v6, 16, v197
  v_and_b32 v7, s39, v197
  v_pk_mul_f32 v[6:7], v[6:7], s[40:41]
  v_cvt_pk_bf16_f32 v197, v6, v7
  v_lshlrev_b32 v6, 16, v198
  v_and_b32 v7, s39, v198
  v_pk_mul_f32 v[6:7], v[6:7], s[40:41]
  v_cvt_pk_bf16_f32 v198, v6, v7
  v_lshlrev_b32 v6, 16, v199
  v_and_b32 v7, s39, v199
  v_pk_mul_f32 v[6:7], v[6:7], s[40:41]
  v_cvt_pk_bf16_f32 v199, v6, v7
  v_lshlrev_b32 v6, 16, v200
  v_and_b32 v7, s39, v200
  v_pk_mul_f32 v[6:7], v[6:7], s[40:41]
  v_cvt_pk_bf16_f32 v200, v6, v7
  v_lshlrev_b32 v6, 16, v201
  v_and_b32 v7, s39, v201
  v_pk_mul_f32 v[6:7], v[6:7], s[40:41]
  v_cvt_pk_bf16_f32 v201, v6, v7
  v_lshlrev_b32 v6, 16, v202
  v_and_b32 v7, s39, v202
  v_pk_mul_f32 v[6:7], v[6:7], s[40:41]
  v_cvt_pk_bf16_f32 v202, v6, v7
  v_lshlrev_b32 v6, 16, v203
  v_and_b32 v7, s39, v203
  v_pk_mul_f32 v[6:7], v[6:7], s[40:41]
  v_cvt_pk_bf16_f32 v203, v6, v7
  v_lshlrev_b32 v6, 16, v204
  v_and_b32 v7, s39, v204
  v_pk_mul_f32 v[6:7], v[6:7], s[40:41]
  v_cvt_pk_bf16_f32 v204, v6, v7
  v_lshlrev_b32 v6, 16, v205
  v_and_b32 v7, s39, v205
  v_pk_mul_f32 v[6:7], v[6:7], s[40:41]
  v_cvt_pk_bf16_f32 v205, v6, v7
  v_lshlrev_b32 v6, 16, v206
  v_and_b32 v7, s39, v206
  v_pk_mul_f32 v[6:7], v[6:7], s[40:41]
  v_cvt_pk_bf16_f32 v206, v6, v7
  v_lshlrev_b32 v6, 16, v207
  v_and_b32 v7, s39, v207
  v_pk_mul_f32 v[6:7], v[6:7], s[40:41]
  v_cvt_pk_bf16_f32 v207, v6, v7
  v_lshlrev_b32 v6, 16, v208
  v_and_b32 v7, s39, v208
  v_pk_mul_f32 v[6:7], v[6:7], s[40:41]
  v_cvt_pk_bf16_f32 v208, v6, v7
  v_lshlrev_b32 v6, 16, v209
  v_and_b32 v7, s39, v209
  v_pk_mul_f32 v[6:7], v[6:7], s[40:41]
  v_cvt_pk_bf16_f32 v209, v6, v7
  v_lshlrev_b32 v6, 16, v210
  v_and_b32 v7, s39, v210
  v_pk_mul_f32 v[6:7], v[6:7], s[40:41]
  v_cvt_pk_bf16_f32 v210, v6, v7
  v_lshlrev_b32 v6, 16, v211
  v_and_b32 v7, s39, v211
  v_pk_mul_f32 v[6:7], v[6:7], s[40:41]
  v_cvt_pk_bf16_f32 v211, v6, v7
  v_lshlrev_b32 v6, 16, v212
  v_and_b32 v7, s39, v212
  v_pk_mul_f32 v[6:7], v[6:7], s[40:41]
  v_cvt_pk_bf16_f32 v212, v6, v7
  v_lshlrev_b32 v6, 16, v213
  v_and_b32 v7, s39, v213
  v_pk_mul_f32 v[6:7], v[6:7], s[40:41]
  v_cvt_pk_bf16_f32 v213, v6, v7
  v_lshlrev_b32 v6, 16, v214
  v_and_b32 v7, s39, v214
  v_pk_mul_f32 v[6:7], v[6:7], s[40:41]
  v_cvt_pk_bf16_f32 v214, v6, v7
  v_lshlrev_b32 v6, 16, v215
  v_and_b32 v7, s39, v215
  v_pk_mul_f32 v[6:7], v[6:7], s[40:41]
  v_cvt_pk_bf16_f32 v215, v6, v7
  v_lshlrev_b32 v6, 16, v216
  v_and_b32 v7, s39, v216
  v_pk_mul_f32 v[6:7], v[6:7], s[40:41]
  v_cvt_pk_bf16_f32 v216, v6, v7
  v_lshlrev_b32 v6, 16, v217
  v_and_b32 v7, s39, v217
  v_pk_mul_f32 v[6:7], v[6:7], s[40:41]
  v_cvt_pk_bf16_f32 v217, v6, v7
  v_lshlrev_b32 v6, 16, v218
  v_and_b32 v7, s39, v218
  v_pk_mul_f32 v[6:7], v[6:7], s[40:41]
  v_cvt_pk_bf16_f32 v218, v6, v7
  v_lshlrev_b32 v6, 16, v219
  v_and_b32 v7, s39, v219
  v_pk_mul_f32 v[6:7], v[6:7], s[40:41]
  v_cvt_pk_bf16_f32 v219, v6, v7
  v_lshlrev_b32 v6, 16, v220
  v_and_b32 v7, s39, v220
  v_pk_mul_f32 v[6:7], v[6:7], s[40:41]
  v_cvt_pk_bf16_f32 v220, v6, v7
  v_lshlrev_b32 v6, 16, v221
  v_and_b32 v7, s39, v221
  v_pk_mul_f32 v[6:7], v[6:7], s[40:41]
  v_cvt_pk_bf16_f32 v221, v6, v7
  v_lshlrev_b32 v6, 16, v222
  v_and_b32 v7, s39, v222
  v_pk_mul_f32 v[6:7], v[6:7], s[40:41]
  v_cvt_pk_bf16_f32 v222, v6, v7
  v_lshlrev_b32 v6, 16, v223
  v_and_b32 v7, s39, v223
  v_pk_mul_f32 v[6:7], v[6:7], s[40:41]
  v_cvt_pk_bf16_f32 v223, v6, v7
  v_lshlrev_b32 v6, 16, v224
  v_and_b32 v7, s39, v224
  v_pk_mul_f32 v[6:7], v[6:7], s[40:41]
  v_cvt_pk_bf16_f32 v224, v6, v7
  v_lshlrev_b32 v6, 16, v225
  v_and_b32 v7, s39, v225
  v_pk_mul_f32 v[6:7], v[6:7], s[40:41]
  v_cvt_pk_bf16_f32 v225, v6, v7
  v_lshlrev_b32 v6, 16, v226
  v_and_b32 v7, s39, v226
  v_pk_mul_f32 v[6:7], v[6:7], s[40:41]
  v_cvt_pk_bf16_f32 v226, v6, v7
  v_lshlrev_b32 v6, 16, v227
  v_and_b32 v7, s39, v227
  v_pk_mul_f32 v[6:7], v[6:7], s[40:41]
  v_cvt_pk_bf16_f32 v227, v6, v7
  v_lshlrev_b32 v6, 16, v228
  v_and_b32 v7, s39, v228
  v_pk_mul_f32 v[6:7], v[6:7], s[40:41]
  v_cvt_pk_bf16_f32 v228, v6, v7
  v_lshlrev_b32 v6, 16, v229
  v_and_b32 v7, s39, v229
  v_pk_mul_f32 v[6:7], v[6:7], s[40:41]
  v_cvt_pk_bf16_f32 v229, v6, v7
  v_lshlrev_b32 v6, 16, v230
  v_and_b32 v7, s39, v230
  v_pk_mul_f32 v[6:7], v[6:7], s[40:41]
  v_cvt_pk_bf16_f32 v230, v6, v7
  v_lshlrev_b32 v6, 16, v231
  v_and_b32 v7, s39, v231
  v_pk_mul_f32 v[6:7], v[6:7], s[40:41]
  v_cvt_pk_bf16_f32 v231, v6, v7
  v_lshlrev_b32 v6, 16, v232
  v_and_b32 v7, s39, v232
  v_pk_mul_f32 v[6:7], v[6:7], s[40:41]
  v_cvt_pk_bf16_f32 v232, v6, v7
  v_lshlrev_b32 v6, 16, v233
  v_and_b32 v7, s39, v233
  v_pk_mul_f32 v[6:7], v[6:7], s[40:41]
  v_cvt_pk_bf16_f32 v233, v6, v7
  v_lshlrev_b32 v6, 16, v234
  v_and_b32 v7, s39, v234
  v_pk_mul_f32 v[6:7], v[6:7], s[40:41]
  v_cvt_pk_bf16_f32 v234, v6, v7
  v_lshlrev_b32 v6, 16, v235
  v_and_b32 v7, s39, v235
  v_pk_mul_f32 v[6:7], v[6:7], s[40:41]
  v_cvt_pk_bf16_f32 v235, v6, v7
  v_lshlrev_b32 v6, 16, v236
  v_and_b32 v7, s39, v236
  v_pk_mul_f32 v[6:7], v[6:7], s[40:41]
  v_cvt_pk_bf16_f32 v236, v6, v7
  v_lshlrev_b32 v6, 16, v237
  v_and_b32 v7, s39, v237
  v_pk_mul_f32 v[6:7], v[6:7], s[40:41]
  v_cvt_pk_bf16_f32 v237, v6, v7
  v_lshlrev_b32 v6, 16, v238
  v_and_b32 v7, s39, v238
  v_pk_mul_f32 v[6:7], v[6:7], s[40:41]
  v_cvt_pk_bf16_f32 v238, v6, v7
  v_lshlrev_b32 v6, 16, v239
  v_and_b32 v7, s39, v239
  v_pk_mul_f32 v[6:7], v[6:7], s[40:41]
  v_cvt_pk_bf16_f32 v239, v6, v7
  v_lshlrev_b32 v6, 16, v240
  v_and_b32 v7, s39, v240
  v_pk_mul_f32 v[6:7], v[6:7], s[40:41]
  v_cvt_pk_bf16_f32 v240, v6, v7
  v_lshlrev_b32 v6, 16, v241
  v_and_b32 v7, s39, v241
  v_pk_mul_f32 v[6:7], v[6:7], s[40:41]
  v_cvt_pk_bf16_f32 v241, v6, v7
  v_lshlrev_b32 v6, 16, v242
  v_and_b32 v7, s39, v242
  v_pk_mul_f32 v[6:7], v[6:7], s[40:41]
  v_cvt_pk_bf16_f32 v242, v6, v7
  v_lshlrev_b32 v6, 16, v243
  v_and_b32 v7, s39, v243
  v_pk_mul_f32 v[6:7], v[6:7], s[40:41]
  v_cvt_pk_bf16_f32 v243, v6, v7
  v_lshlrev_b32 v6, 16, v244
  v_and_b32 v7, s39, v244
  v_pk_mul_f32 v[6:7], v[6:7], s[40:41]
  v_cvt_pk_bf16_f32 v244, v6, v7
  v_lshlrev_b32 v6, 16, v245
  v_and_b32 v7, s39, v245
  v_pk_mul_f32 v[6:7], v[6:7], s[40:41]
  v_cvt_pk_bf16_f32 v245, v6, v7
  v_lshlrev_b32 v6, 16, v246
  v_and_b32 v7, s39, v246
  v_pk_mul_f32 v[6:7], v[6:7], s[40:41]
  v_cvt_pk_bf16_f32 v246, v6, v7
  v_lshlrev_b32 v6, 16, v247
  v_and_b32 v7, s39, v247
  v_pk_mul_f32 v[6:7], v[6:7], s[40:41]
  v_cvt_pk_bf16_f32 v247, v6, v7
  v_lshlrev_b32 v6, 16, v248
  v_and_b32 v7, s39, v248
  v_pk_mul_f32 v[6:7], v[6:7], s[40:41]
  v_cvt_pk_bf16_f32 v248, v6, v7
  v_lshlrev_b32 v6, 16, v249
  v_and_b32 v7, s39, v249
  v_pk_mul_f32 v[6:7], v[6:7], s[40:41]
  v_cvt_pk_bf16_f32 v249, v6, v7
  v_lshlrev_b32 v6, 16, v250
  v_and_b32 v7, s39, v250
  v_pk_mul_f32 v[6:7], v[6:7], s[40:41]
  v_cvt_pk_bf16_f32 v250, v6, v7
  v_lshlrev_b32 v6, 16, v251
  v_and_b32 v7, s39, v251
  v_pk_mul_f32 v[6:7], v[6:7], s[40:41]
  v_cvt_pk_bf16_f32 v251, v6, v7
  v_lshlrev_b32 v6, 16, v252
  v_and_b32 v7, s39, v252
  v_pk_mul_f32 v[6:7], v[6:7], s[40:41]
  v_cvt_pk_bf16_f32 v252, v6, v7
  v_lshlrev_b32 v6, 16, v253
  v_and_b32 v7, s39, v253
  v_pk_mul_f32 v[6:7], v[6:7], s[40:41]
  v_cvt_pk_bf16_f32 v253, v6, v7
  v_lshlrev_b32 v6, 16, v254
  v_and_b32 v7, s39, v254
  v_pk_mul_f32 v[6:7], v[6:7], s[40:41]
  v_cvt_pk_bf16_f32 v254, v6, v7
  v_lshlrev_b32 v6, 16, v255
  v_and_b32 v7, s39, v255
  v_pk_mul_f32 v[6:7], v[6:7], s[40:41]
  v_cvt_pk_bf16_f32 v255, v6, v7
  v_mov_b32 v8, 0xff800000
  v_mov_b32 v9, 0xff800000
  v_mov_b32 v10, 0xff800000
  v_mov_b32 v11, 0xff800000
  s_mov_b32 s29, s34
  s_mov_b32 s31, 32
L_fb1:
  s_barrier
  s_mov_b32 m0, s34
  s_nop 0
  buffer_load_dwordx4 v180, s[16:19], s29 offen offset:0 lds
  buffer_load_dwordx4 v180, s[16:19], s29 offen offset:1024 lds
  buffer_load_dwordx4 v180, s[16:19], s29 offen offset:2048 lds
  buffer_load_dwordx4 v180, s[16:19], s29 offen offset:3072 lds
  s_addk_i32 s29, 0x4000
  s_waitcnt vmcnt(0)
  s_barrier
  ds_read_b128 a[128:131], v168 offset:0
  ds_read_b128 a[132:135], v169 offset:0
  ds_read_b128 a[136:139], v170 offset:0
  ds_read_b128 a[140:143], v171 offset:0
  ds_read_b128 a[144:147], v168 offset:1024
  ds_read_b128 a[148:151], v169 offset:1024
  ds_read_b128 a[152:155], v170 offset:1024
  ds_read_b128 a[156:159], v171 offset:1024
  ds_read_b128 a[160:163], v168 offset:2048
  ds_read_b128 a[164:167], v169 offset:2048
  ds_read_b128 a[168:171], v170 offset:2048
  ds_read_b128 a[172:175], v171 offset:2048
  ds_read_b128 a[176:179], v168 offset:3072
  ds_read_b128 a[180:183], v169 offset:3072
  ds_read_b128 a[184:187], v170 offset:3072
  ds_read_b128 a[188:191], v171 offset:3072
  s_waitcnt lgkmcnt(0)
  v_mfma_f32_16x16x32_bf16 v[16:19], a[128:131], v[192:195], 0
  v_mfma_f32_16x16x32_bf16 v[16:19], a[132:135], v[196:199], v[16:19]
  v_mfma_f32_16x16x32_bf16 v[16:19], a[136:139], v[200:203], v[16:19]
  v_mfma_f32_16x16x32_bf16 v[16:19], a[140:143], v[204:207], v[16:19]
  v_mfma_f32_16x16x32_bf16 v[32:35], a[144:147], v[192:195], 0
  v_mfma_f32_16x16x32_bf16 v[32:35], a[148:151], v[196:199], v[32:35]
  v_mfma_f32_16x16x32_bf16 v[32:35], a[152:155], v[200:203], v[32:35]
  v_mfma_f32_16x16x32_bf16 v[32:35], a[156:159], v[204:207], v[32:35]
  v_mfma_f32_16x16x32_bf16 v[48:51], a[160:163], v[192:195], 0
  v_mfma_f32_16x16x32_bf16 v[48:51], a[164:167], v[196:199], v[48:51]
  v_mfma_f32_16x16x32_bf16 v[48:51], a[168:171], v[200:203], v[48:51]
  v_mfma_f32_16x16x32_bf16 v[48:51], a[172:175], v[204:207], v[48:51]
  v_mfma_f32_16x16x32_bf16 v[64:67], a[176:179], v[192:195], 0
  v_mfma_f32_16x16x32_bf16 v[64:67], a[180:183], v[196:199], v[64:67]
  v_mfma_f32_16x16x32_bf16 v[64:67], a[184:187], v[200:203], v[64:67]
  v_mfma_f32_16x16x32_bf16 v[64:67], a[188:191], v[204:207], v[64:67]
  v_mfma_f32_16x16x32_bf16 v[20:23], a[128:131], v[208:211], 0
  v_mfma_f32_16x16x32_bf16 v[20:23], a[132:135], v[212:215], v[20:23]
  v_mfma_f32_16x16x32_bf16 v[20:23], a[136:139], v[216:219], v[20:23]
  v_mfma_f32_16x16x32_bf16 v[20:23], a[140:143], v[220:223], v[20:23]
  v_mfma_f32_16x16x32_bf16 v[36:39], a[144:147], v[208:211], 0
  v_mfma_f32_16x16x32_bf16 v[36:39], a[148:151], v[212:215], v[36:39]
  v_mfma_f32_16x16x32_bf16 v[36:39], a[152:155], v[216:219], v[36:39]
  v_mfma_f32_16x16x32_bf16 v[36:39], a[156:159], v[220:223], v[36:39]
  v_mfma_f32_16x16x32_bf16 v[52:55], a[160:163], v[208:211], 0
  v_mfma_f32_16x16x32_bf16 v[52:55], a[164:167], v[212:215], v[52:55]
  v_mfma_f32_16x16x32_bf16 v[52:55], a[168:171], v[216:219], v[52:55]
  v_mfma_f32_16x16x32_bf16 v[52:55], a[172:175], v[220:223], v[52:55]
  v_mfma_f32_16x16x32_bf16 v[68:71], a[176:179], v[208:211], 0
  v_mfma_f32_16x16x32_bf16 v[68:71], a[180:183], v[212:215], v[68:71]
  v_mfma_f32_16x16x32_bf16 v[68:71], a[184:187], v[216:219], v[68:71]
  v_mfma_f32_16x16x32_bf16 v[68:71], a[188:191], v[220:223], v[68:71]
  v_mfma_f32_16x16x32_bf16 v[24:27], a[128:131], v[224:227], 0
  v_mfma_f32_16x16x32_bf16 v[24:27], a[132:135], v[228:231], v[24:27]
  v_mfma_f32_16x16x32_bf16 v[24:27], a[136:139], v[232:235], v[24:27]
  v_mfma_f32_16x16x32_bf16 v[24:27], a[140:143], v[236:239], v[24:27]
  v_mfma_f32_16x16x32_bf16 v[40:43], a[144:147], v[224:227], 0
  v_mfma_f32_16x16x32_bf16 v[40:43], a[148:151], v[228:231], v[40:43]
  v_mfma_f32_16x16x32_bf16 v[40:43], a[152:155], v[232:235], v[40:43]
  v_mfma_f32_16x16x32_bf16 v[40:43], a[156:159], v[236:239], v[40:43]
  v_mfma_f32_16x16x32_bf16 v[56:59], a[160:163], v[224:227], 0
  v_mfma_f32_16x16x32_bf16 v[56:59], a[164:167], v[228:231], v[56:59]
  v_mfma_f32_16x16x32_bf16 v[56:59], a[168:171], v[232:235], v[56:59]
  v_mfma_f32_16x16x32_bf16 v[56:59], a[172:175], v[236:239], v[56:59]
  v_mfma_f32_16x16x32_bf16 v[72:75], a[176:179], v[224:227], 0
  v_mfma_f32_16x16x32_bf16 v[72:75], a[180:183], v[228:231], v[72:75]
  v_mfma_f32_16x16x32_bf16 v[72:75], a[184:187], v[232:235], v[72:75]
  v_mfma_f32_16x16x32_bf16 v[72:75], a[188:191], v[236:239], v[72:75]
  v_mfma_f32_16x16x32_bf16 v[28:31], a[128:131], v[240:243], 0
  v_mfma_f32_16x16x32_bf16 v[28:31], a[132:135], v[244:247], v[28:31]
  v_mfma_f32_16x16x32_bf16 v[28:31], a[136:139], v[248:251], v[28:31]
  v_mfma_f32_16x16x32_bf16 v[28:31], a[140:143], v[252:255], v[28:31]
  v_mfma_f32_16x16x32_bf16 v[44:47], a[144:147], v[240:243], 0
  v_mfma_f32_16x16x32_bf16 v[44:47], a[148:151], v[244:247], v[44:47]
  v_mfma_f32_16x16x32_bf16 v[44:47], a[152:155], v[248:251], v[44:47]
  v_mfma_f32_16x16x32_bf16 v[44:47], a[156:159], v[252:255], v[44:47]
  v_mfma_f32_16x16x32_bf16 v[60:63], a[160:163], v[240:243], 0
  v_mfma_f32_16x16x32_bf16 v[60:63], a[164:167], v[244:247], v[60:63]
  v_mfma_f32_16x16x32_bf16 v[60:63], a[168:171], v[248:251], v[60:63]
  v_mfma_f32_16x16x32_bf16 v[60:63], a[172:175], v[252:255], v[60:63]
  v_mfma_f32_16x16x32_bf16 v[76:79], a[176:179], v[240:243], 0
  v_mfma_f32_16x16x32_bf16 v[76:79], a[180:183], v[244:247], v[76:79]
  v_mfma_f32_16x16x32_bf16 v[76:79], a[184:187], v[248:251], v[76:79]
  v_mfma_f32_16x16x32_bf16 v[76:79], a[188:191], v[252:255], v[76:79]
  s_nop 7
  v_max3_f32 v8, v8, v16, v17
  v_max3_f32 v8, v8, v18, v19
  v_max3_f32 v8, v8, v32, v33
  v_max3_f32 v8, v8, v34, v35
  v_max3_f32 v8, v8, v48, v49
  v_max3_f32 v8, v8, v50, v51
  v_max3_f32 v8, v8, v64, v65
  v_max3_f32 v8, v8, v66, v67
  v_max3_f32 v9, v9, v20, v21
  v_max3_f32 v9, v9, v22, v23
  v_max3_f32 v9, v9, v36, v37
  v_max3_f32 v9, v9, v38, v39
  v_max3_f32 v9, v9, v52, v53
  v_max3_f32 v9, v9, v54, v55
  v_max3_f32 v9, v9, v68, v69
  v_max3_f32 v9, v9, v70, v71
  v_max3_f32 v10, v10, v24, v25
  v_max3_f32 v10, v10, v26, v27
  v_max3_f32 v10, v10, v40, v41
  v_max3_f32 v10, v10, v42, v43
  v_max3_f32 v10, v10, v56, v57
  v_max3_f32 v10, v10, v58, v59
  v_max3_f32 v10, v10, v72, v73
  v_max3_f32 v10, v10, v74, v75
  v_max3_f32 v11, v11, v28, v29
  v_max3_f32 v11, v11, v30, v31
  v_max3_f32 v11, v11, v44, v45
  v_max3_f32 v11, v11, v46, v47
  v_max3_f32 v11, v11, v60, v61
  v_max3_f32 v11, v11, v62, v63
  v_max3_f32 v11, v11, v76, v77
  v_max3_f32 v11, v11, v78, v79
  s_sub_u32 s31, s31, 1
  s_cmp_lg_u32 s31, 0
  s_cbranch_scc1 L_fb1
  v_mov_b32 v5, v8
  s_nop 1
  v_permlane16_swap_b32 v8, v5
  v_max_f32 v8, v8, v5
  v_mov_b32 v5, v8
  s_nop 1
  v_permlane32_swap_b32 v8, v5
  v_max_f32 v8, v8, v5
  v_sub_f32 v144, 0, v8
  v_sub_f32 v145, 0, v8
  v_sub_f32 v146, 0, v8
  v_sub_f32 v147, 0, v8
  v_mov_b32 v5, v9
  s_nop 1
  v_permlane16_swap_b32 v9, v5
  v_max_f32 v9, v9, v5
  v_mov_b32 v5, v9
  s_nop 1
  v_permlane32_swap_b32 v9, v5
  v_max_f32 v9, v9, v5
  v_sub_f32 v148, 0, v9
  v_sub_f32 v149, 0, v9
  v_sub_f32 v150, 0, v9
  v_sub_f32 v151, 0, v9
  v_mov_b32 v5, v10
  s_nop 1
  v_permlane16_swap_b32 v10, v5
  v_max_f32 v10, v10, v5
  v_mov_b32 v5, v10
  s_nop 1
  v_permlane32_swap_b32 v10, v5
  v_max_f32 v10, v10, v5
  v_sub_f32 v152, 0, v10
  v_sub_f32 v153, 0, v10
  v_sub_f32 v154, 0, v10
  v_sub_f32 v155, 0, v10
  v_mov_b32 v5, v11
  s_nop 1
  v_permlane16_swap_b32 v11, v5
  v_max_f32 v11, v11, v5
  v_mov_b32 v5, v11
  s_nop 1
  v_permlane32_swap_b32 v11, v5
  v_max_f32 v11, v11, v5
  v_sub_f32 v156, 0, v11
  v_sub_f32 v157, 0, v11
  v_sub_f32 v158, 0, v11
  v_sub_f32 v159, 0, v11
  s_mov_b32 s43, 0
  v_accvgpr_write_b32 a0, 0
  v_accvgpr_write_b32 a1, 0
  v_accvgpr_write_b32 a2, 0
  v_accvgpr_write_b32 a3, 0
  v_accvgpr_write_b32 a4, 0
  v_accvgpr_write_b32 a5, 0
  v_accvgpr_write_b32 a6, 0
  v_accvgpr_write_b32 a7, 0
  v_accvgpr_write_b32 a8, 0
  v_accvgpr_write_b32 a9, 0
  v_accvgpr_write_b32 a10, 0
  v_accvgpr_write_b32 a11, 0
  v_accvgpr_write_b32 a12, 0
  v_accvgpr_write_b32 a13, 0
  v_accvgpr_write_b32 a14, 0
  v_accvgpr_write_b32 a15, 0
  v_accvgpr_write_b32 a16, 0
  v_accvgpr_write_b32 a17, 0
  v_accvgpr_write_b32 a18, 0
  v_accvgpr_write_b32 a19, 0
  v_accvgpr_write_b32 a20, 0
  v_accvgpr_write_b32 a21, 0
  v_accvgpr_write_b32 a22, 0
  v_accvgpr_write_b32 a23, 0
  v_accvgpr_write_b32 a24, 0
  v_accvgpr_write_b32 a25, 0
  v_accvgpr_write_b32 a26, 0
  v_accvgpr_write_b32 a27, 0
  v_accvgpr_write_b32 a28, 0
  v_accvgpr_write_b32 a29, 0
  v_accvgpr_write_b32 a30, 0
  v_accvgpr_write_b32 a31, 0
  v_accvgpr_write_b32 a32, 0
  v_accvgpr_write_b32 a33, 0
  v_accvgpr_write_b32 a34, 0
  v_accvgpr_write_b32 a35, 0
  v_accvgpr_write_b32 a36, 0
  v_accvgpr_write_b32 a37, 0
  v_accvgpr_write_b32 a38, 0
  v_accvgpr_write_b32 a39, 0
  v_accvgpr_write_b32 a40, 0
  v_accvgpr_write_b32 a41, 0
  v_accvgpr_write_b32 a42, 0
  v_accvgpr_write_b32 a43, 0
  v_accvgpr_write_b32 a44, 0
  v_accvgpr_write_b32 a45, 0
  v_accvgpr_write_b32 a46, 0
  v_accvgpr_write_b32 a47, 0
  v_accvgpr_write_b32 a48, 0
  v_accvgpr_write_b32 a49, 0
  v_accvgpr_write_b32 a50, 0
  v_accvgpr_write_b32 a51, 0
  v_accvgpr_write_b32 a52, 0
  v_accvgpr_write_b32 a53, 0
  v_accvgpr_write_b32 a54, 0
  v_accvgpr_write_b32 a55, 0
  v_accvgpr_write_b32 a56, 0
  v_accvgpr_write_b32 a57, 0
  v_accvgpr_write_b32 a58, 0
  v_accvgpr_write_b32 a59, 0
  v_accvgpr_write_b32 a60, 0
  v_accvgpr_write_b32 a61, 0
  v_accvgpr_write_b32 a62, 0
  v_accvgpr_write_b32 a63, 0
  v_accvgpr_write_b32 a64, 0
  v_accvgpr_write_b32 a65, 0
  v_accvgpr_write_b32 a66, 0
  v_accvgpr_write_b32 a67, 0
  v_accvgpr_write_b32 a68, 0
  v_accvgpr_write_b32 a69, 0
  v_accvgpr_write_b32 a70, 0
  v_accvgpr_write_b32 a71, 0
  v_accvgpr_write_b32 a72, 0
  v_accvgpr_write_b32 a73, 0
  v_accvgpr_write_b32 a74, 0
  v_accvgpr_write_b32 a75, 0
  v_accvgpr_write_b32 a76, 0
  v_accvgpr_write_b32 a77, 0
  v_accvgpr_write_b32 a78, 0
  v_accvgpr_write_b32 a79, 0
  v_accvgpr_write_b32 a80, 0
  v_accvgpr_write_b32 a81, 0
  v_accvgpr_write_b32 a82, 0
  v_accvgpr_write_b32 a83, 0
  v_accvgpr_write_b32 a84, 0
  v_accvgpr_write_b32 a85, 0
  v_accvgpr_write_b32 a86, 0
  v_accvgpr_write_b32 a87, 0
  v_accvgpr_write_b32 a88, 0
  v_accvgpr_write_b32 a89, 0
  v_accvgpr_write_b32 a90, 0
  v_accvgpr_write_b32 a91, 0
  v_accvgpr_write_b32 a92, 0
  v_accvgpr_write_b32 a93, 0
  v_accvgpr_write_b32 a94, 0
  v_accvgpr_write_b32 a95, 0
  v_accvgpr_write_b32 a96, 0
  v_accvgpr_write_b32 a97, 0
  v_accvgpr_write_b32 a98, 0
  v_accvgpr_write_b32 a99, 0
  v_accvgpr_write_b32 a100, 0
  v_accvgpr_write_b32 a101, 0
  v_accvgpr_write_b32 a102, 0
  v_accvgpr_write_b32 a103, 0
  v_accvgpr_write_b32 a104, 0
  v_accvgpr_write_b32 a105, 0
  v_accvgpr_write_b32 a106, 0
  v_accvgpr_write_b32 a107, 0
  v_accvgpr_write_b32 a108, 0
  v_accvgpr_write_b32 a109, 0
  v_accvgpr_write_b32 a110, 0
  v_accvgpr_write_b32 a111, 0
  v_accvgpr_write_b32 a112, 0
  v_accvgpr_write_b32 a113, 0
  v_accvgpr_write_b32 a114, 0
  v_accvgpr_write_b32 a115, 0
  v_accvgpr_write_b32 a116, 0
  v_accvgpr_write_b32 a117, 0
  v_accvgpr_write_b32 a118, 0
  v_accvgpr_write_b32 a119, 0
  v_accvgpr_write_b32 a120, 0
  v_accvgpr_write_b32 a121, 0
  v_accvgpr_write_b32 a122, 0
  v_accvgpr_write_b32 a123, 0
  v_accvgpr_write_b32 a124, 0
  v_accvgpr_write_b32 a125, 0
  v_accvgpr_write_b32 a126, 0
  v_accvgpr_write_b32 a127, 0
  v_accvgpr_write_b32 a224, 0
  v_accvgpr_write_b32 a225, 0
  v_accvgpr_write_b32 a226, 0
  v_accvgpr_write_b32 a227, 0
  v_accvgpr_write_b32 a228, 0
  v_accvgpr_write_b32 a229, 0
  v_accvgpr_write_b32 a230, 0
  v_accvgpr_write_b32 a231, 0
  v_accvgpr_write_b32 a232, 0
  v_accvgpr_write_b32 a233, 0
  v_accvgpr_write_b32 a234, 0
  v_accvgpr_write_b32 a235, 0
  v_accvgpr_write_b32 a236, 0
  v_accvgpr_write_b32 a237, 0
  v_accvgpr_write_b32 a238, 0
  v_accvgpr_write_b32 a239, 0
  s_mov_b32 s29, s34
  s_mov_b32 s30, s34
  s_mov_b32 s31, 15
  s_barrier
  s_pack_ll_b32_b16 m0, s29, 0
  s_nop 0
  buffer_load_dwordx4 v180, s[16:19], s29 offen offset:0 lds
  buffer_load_dwordx4 v180, s[16:19], s29 offen offset:1024 lds
  buffer_load_dwordx4 v180, s[16:19], s29 offen offset:2048 lds
  buffer_load_dwordx4 v180, s[16:19], s29 offen offset:3072 lds
  s_addk_i32 s29, 0x4000
  s_pack_ll_b32_b16 m0, s29, 0
  s_nop 0
  buffer_load_dwordx4 v180, s[16:19], s29 offen offset:0 lds
  buffer_load_dwordx4 v180, s[16:19], s29 offen offset:1024 lds
  buffer_load_dwordx4 v180, s[16:19], s29 offen offset:2048 lds
  buffer_load_dwordx4 v180, s[16:19], s29 offen offset:3072 lds
  s_addk_i32 s29, 0x4000
  s_pack_ll_b32_b16 m0, s30, 1
  s_nop 0
  buffer_load_dwordx4 v181, s[20:23], s30 offen offset:0 lds
  buffer_load_dwordx4 v181, s[20:23], s30 offen offset:1024 lds
  buffer_load_dwordx4 v181, s[20:23], s30 offen offset:2048 lds
  buffer_load_dwordx4 v181, s[20:23], s30 offen offset:3072 lds
  s_addk_i32 s30, 0x4000
  s_pack_ll_b32_b16 m0, s29, 0
  s_nop 0
  buffer_load_dwordx4 v180, s[16:19], s29 offen offset:0 lds
  buffer_load_dwordx4 v180, s[16:19], s29 offen offset:1024 lds
  buffer_load_dwordx4 v180, s[16:19], s29 offen offset:2048 lds
  buffer_load_dwordx4 v180, s[16:19], s29 offen offset:3072 lds
  s_addk_i32 s29, 0x4000
  s_pack_ll_b32_b16 m0, s30, 1
  s_nop 0
  buffer_load_dwordx4 v181, s[20:23], s30 offen offset:0 lds
  buffer_load_dwordx4 v181, s[20:23], s30 offen offset:1024 lds
  buffer_load_dwordx4 v181, s[20:23], s30 offen offset:2048 lds
  buffer_load_dwordx4 v181, s[20:23], s30 offen offset:3072 lds
  s_addk_i32 s30, 0x4000
  s_waitcnt vmcnt(0)
  s_barrier
  ds_read_b128 a[128:131], v168 offset:0
  ds_read_b128 a[132:135], v169 offset:0
  ds_read_b128 a[136:139], v170 offset:0
  ds_read_b128 a[140:143], v171 offset:0
  ds_read_b128 a[144:147], v168 offset:1024
  ds_read_b128 a[148:151], v169 offset:1024
  ds_read_b128 a[152:155], v170 offset:1024
  ds_read_b128 a[156:159], v171 offset:1024
  ds_read_b128 a[160:163], v168 offset:2048
  ds_read_b128 a[164:167], v169 offset:2048
  ds_read_b128 a[168:171], v170 offset:2048
  ds_read_b128 a[172:175], v171 offset:2048
  ds_read_b128 a[176:179], v168 offset:3072
  ds_read_b128 a[180:183], v169 offset:3072
  ds_read_b128 a[184:187], v170 offset:3072
  ds_read_b128 a[188:191], v171 offset:3072
  s_waitcnt lgkmcnt(0)
  v_mfma_f32_16x16x32_bf16 v[16:19], a[128:131], v[192:195], v[144:147]
  v_mfma_f32_16x16x32_bf16 v[16:19], a[132:135], v[196:199], v[16:19]
  v_mfma_f32_16x16x32_bf16 v[16:19], a[136:139], v[200:203], v[16:19]
  v_mfma_f32_16x16x32_bf16 v[16:19], a[140:143], v[204:207], v[16:19]
  v_mfma_f32_16x16x32_bf16 v[32:35], a[144:147], v[192:195], v[144:147]
  v_mfma_f32_16x16x32_bf16 v[32:35], a[148:151], v[196:199], v[32:35]
  v_mfma_f32_16x16x32_bf16 v[32:35], a[152:155], v[200:203], v[32:35]
  v_mfma_f32_16x16x32_bf16 v[32:35], a[156:159], v[204:207], v[32:35]
  v_mfma_f32_16x16x32_bf16 v[48:51], a[160:163], v[192:195], v[144:147]
  v_mfma_f32_16x16x32_bf16 v[48:51], a[164:167], v[196:199], v[48:51]
  v_mfma_f32_16x16x32_bf16 v[48:51], a[168:171], v[200:203], v[48:51]
  v_mfma_f32_16x16x32_bf16 v[48:51], a[172:175], v[204:207], v[48:51]
  v_mfma_f32_16x16x32_bf16 v[64:67], a[176:179], v[192:195], v[144:147]
  v_mfma_f32_16x16x32_bf16 v[64:67], a[180:183], v[196:199], v[64:67]
  v_mfma_f32_16x16x32_bf16 v[64:67], a[184:187], v[200:203], v[64:67]
  v_mfma_f32_16x16x32_bf16 v[64:67], a[188:191], v[204:207], v[64:67]
  v_mfma_f32_16x16x32_bf16 v[20:23], a[128:131], v[208:211], v[148:151]
  v_mfma_f32_16x16x32_bf16 v[20:23], a[132:135], v[212:215], v[20:23]
  v_mfma_f32_16x16x32_bf16 v[20:23], a[136:139], v[216:219], v[20:23]
  v_mfma_f32_16x16x32_bf16 v[20:23], a[140:143], v[220:223], v[20:23]
  v_mfma_f32_16x16x32_bf16 v[36:39], a[144:147], v[208:211], v[148:151]
  v_mfma_f32_16x16x32_bf16 v[36:39], a[148:151], v[212:215], v[36:39]
  v_mfma_f32_16x16x32_bf16 v[36:39], a[152:155], v[216:219], v[36:39]
  v_mfma_f32_16x16x32_bf16 v[36:39], a[156:159], v[220:223], v[36:39]
  v_mfma_f32_16x16x32_bf16 v[52:55], a[160:163], v[208:211], v[148:151]
  v_mfma_f32_16x16x32_bf16 v[52:55], a[164:167], v[212:215], v[52:55]
  v_mfma_f32_16x16x32_bf16 v[52:55], a[168:171], v[216:219], v[52:55]
  v_mfma_f32_16x16x32_bf16 v[52:55], a[172:175], v[220:223], v[52:55]
  v_mfma_f32_16x16x32_bf16 v[68:71], a[176:179], v[208:211], v[148:151]
  v_mfma_f32_16x16x32_bf16 v[68:71], a[180:183], v[212:215], v[68:71]
  v_mfma_f32_16x16x32_bf16 v[68:71], a[184:187], v[216:219], v[68:71]
  v_mfma_f32_16x16x32_bf16 v[68:71], a[188:191], v[220:223], v[68:71]
  v_mfma_f32_16x16x32_bf16 v[24:27], a[128:131], v[224:227], v[152:155]
  v_mfma_f32_16x16x32_bf16 v[24:27], a[132:135], v[228:231], v[24:27]
  v_mfma_f32_16x16x32_bf16 v[24:27], a[136:139], v[232:235], v[24:27]
  v_mfma_f32_16x16x32_bf16 v[24:27], a[140:143], v[236:239], v[24:27]
  v_mfma_f32_16x16x32_bf16 v[40:43], a[144:147], v[224:227], v[152:155]
  v_mfma_f32_16x16x32_bf16 v[40:43], a[148:151], v[228:231], v[40:43]
  v_mfma_f32_16x16x32_bf16 v[40:43], a[152:155], v[232:235], v[40:43]
  v_mfma_f32_16x16x32_bf16 v[40:43], a[156:159], v[236:239], v[40:43]
  v_mfma_f32_16x16x32_bf16 v[56:59], a[160:163], v[224:227], v[152:155]
  v_mfma_f32_16x16x32_bf16 v[56:59], a[164:167], v[228:231], v[56:59]
  v_mfma_f32_16x16x32_bf16 v[56:59], a[168:171], v[232:235], v[56:59]
  v_mfma_f32_16x16x32_bf16 v[56:59], a[172:175], v[236:239], v[56:59]
  v_mfma_f32_16x16x32_bf16 v[72:75], a[176:179], v[224:227], v[152:155]
  v_mfma_f32_16x16x32_bf16 v[72:75], a[180:183], v[228:231], v[72:75]
  v_mfma_f32_16x16x32_bf16 v[72:75], a[184:187], v[232:235], v[72:75]
  v_mfma_f32_16x16x32_bf16 v[72:75], a[188:191], v[236:239], v[72:75]
  v_mfma_f32_16x16x32_bf16 v[28:31], a[128:131], v[240:243], v[156:159]
  v_mfma_f32_16x16x32_bf16 v[28:31], a[132:135], v[244:247], v[28:31]
  v_mfma_f32_16x16x32_bf16 v[28:31], a[136:139], v[248:251], v[28:31]
  v_mfma_f32_16x16x32_bf16 v[28:31], a[140:143], v[252:255], v[28:31]
  v_mfma_f32_16x16x32_bf16 v[44:47], a[144:147], v[240:243], v[156:159]
  v_mfma_f32_16x16x32_bf16 v[44:47], a[148:151], v[244:247], v[44:47]
  v_mfma_f32_16x16x32_bf16 v[44:47], a[152:155], v[248:251], v[44:47]
  v_mfma_f32_16x16x32_bf16 v[44:47], a[156:159], v[252:255], v[44:47]
  v_mfma_f32_16x16x32_bf16 v[60:63], a[160:163], v[240:243], v[156:159]
  v_mfma_f32_16x16x32_bf16 v[60:63], a[164:167], v[244:247], v[60:63]
  v_mfma_f32_16x16x32_bf16 v[60:63], a[168:171], v[248:251], v[60:63]
  v_mfma_f32_16x16x32_bf16 v[60:63], a[172:175], v[252:255], v[60:63]
  v_mfma_f32_16x16x32_bf16 v[76:79], a[176:179], v[240:243], v[156:159]
  v_mfma_f32_16x16x32_bf16 v[76:79], a[180:183], v[244:247], v[76:79]
  v_mfma_f32_16x16x32_bf16 v[76:79], a[184:187], v[248:251], v[76:79]
  v_mfma_f32_16x16x32_bf16 v[76:79], a[188:191], v[252:255], v[76:79]
  s_nop 7
  v_exp_f32 v16, v16
  v_exp_f32 v17, v17
  v_exp_f32 v18, v18
  v_exp_f32 v19, v19
  v_exp_f32 v32, v32
  v_exp_f32 v33, v33
  v_exp_f32 v34, v34
  v_exp_f32 v35, v35
  v_exp_f32 v48, v48
  v_exp_f32 v49, v49
  v_exp_f32 v50, v50
  v_exp_f32 v51, v51
  v_exp_f32 v64, v64
  v_exp_f32 v65, v65
  v_exp_f32 v66, v66
  v_exp_f32 v67, v67
  v_cvt_pk_bf16_f32 v80, v16, v17
  v_cvt_pk_bf16_f32 v81, v18, v19
  v_cvt_pk_bf16_f32 v82, v32, v33
  v_cvt_pk_bf16_f32 v83, v34, v35
  v_cvt_pk_bf16_f32 v84, v48, v49
  v_cvt_pk_bf16_f32 v85, v50, v51
  v_cvt_pk_bf16_f32 v86, v64, v65
  v_cvt_pk_bf16_f32 v87, v66, v67
  v_exp_f32 v20, v20
  v_exp_f32 v21, v21
  v_exp_f32 v22, v22
  v_exp_f32 v23, v23
  v_exp_f32 v36, v36
  v_exp_f32 v37, v37
  v_exp_f32 v38, v38
  v_exp_f32 v39, v39
  v_exp_f32 v52, v52
  v_exp_f32 v53, v53
  v_exp_f32 v54, v54
  v_exp_f32 v55, v55
  v_exp_f32 v68, v68
  v_exp_f32 v69, v69
  v_exp_f32 v70, v70
  v_exp_f32 v71, v71
  v_cvt_pk_bf16_f32 v88, v20, v21
  v_cvt_pk_bf16_f32 v89, v22, v23
  v_cvt_pk_bf16_f32 v90, v36, v37
  v_cvt_pk_bf16_f32 v91, v38, v39
  v_cvt_pk_bf16_f32 v92, v52, v53
  v_cvt_pk_bf16_f32 v93, v54, v55
  v_cvt_pk_bf16_f32 v94, v68, v69
  v_cvt_pk_bf16_f32 v95, v70, v71
  v_exp_f32 v24, v24
  v_exp_f32 v25, v25
  v_exp_f32 v26, v26
  v_exp_f32 v27, v27
  v_exp_f32 v40, v40
  v_exp_f32 v41, v41
  v_exp_f32 v42, v42
  v_exp_f32 v43, v43
  v_exp_f32 v56, v56
  v_exp_f32 v57, v57
  v_exp_f32 v58, v58
  v_exp_f32 v59, v59
  v_exp_f32 v72, v72
  v_exp_f32 v73, v73
  v_exp_f32 v74, v74
  v_exp_f32 v75, v75
  v_cvt_pk_bf16_f32 v96, v24, v25
  v_cvt_pk_bf16_f32 v97, v26, v27
  v_cvt_pk_bf16_f32 v98, v40, v41
  v_cvt_pk_bf16_f32 v99, v42, v43
  v_cvt_pk_bf16_f32 v100, v56, v57
  v_cvt_pk_bf16_f32 v101, v58, v59
  v_cvt_pk_bf16_f32 v102, v72, v73
  v_cvt_pk_bf16_f32 v103, v74, v75
  v_exp_f32 v28, v28
  v_exp_f32 v29, v29
  v_exp_f32 v30, v30
  v_exp_f32 v31, v31
  v_exp_f32 v44, v44
  v_exp_f32 v45, v45
  v_exp_f32 v46, v46
  v_exp_f32 v47, v47
  v_exp_f32 v60, v60
  v_exp_f32 v61, v61
  v_exp_f32 v62, v62
  v_exp_f32 v63, v63
  v_cvt_pk_bf16_f32 v104, v28, v29
  v_cvt_pk_bf16_f32 v105, v30, v31
  v_cvt_pk_bf16_f32 v106, v44, v45
  v_cvt_pk_bf16_f32 v107, v46, v47
  v_cvt_pk_bf16_f32 v108, v60, v61
  v_cvt_pk_bf16_f32 v109, v62, v63
  s_barrier
  ds_read_b128 a[192:195], v168 offset:16384
  ds_read_b128 a[196:199], v169 offset:16384
  ds_read_b128 a[200:203], v170 offset:16384
  ds_read_b128 a[204:207], v171 offset:16384
  s_waitcnt lgkmcnt(0)
  s_nop 7
  s_branch L_entry
.section .rodata,"a"
.p2align 6
.amdhsa_kernel standalone__gqa_softmax__prompt_kernel
  .amdhsa_next_free_vgpr 512
  .amdhsa_next_free_sgpr 102
  .amdhsa_accum_offset 256
  .amdhsa_group_segment_fixed_size 0
  .amdhsa_kernarg_size 48
  .amdhsa_user_sgpr_count 2
  .amdhsa_user_sgpr_kernarg_segment_ptr 1
  .amdhsa_system_sgpr_workgroup_id_x 1
.end_amdhsa_kernel
```
